```python
import torch

def _softmax(x, axis=-1):
    return torch.softmax(x, dim=axis)
def _gelu(x):
    return torch.nn.functional.gelu(x, approximate="tanh")
def _silu(x):
    return torch.nn.functional.silu(x)
def _sigmoid(x):
    return torch.sigmoid(x)
def _layernorm(x, axis=-1, eps=1e-5):
    m = x.mean(dim=axis, keepdim=True)
    v = x.var(dim=axis, keepdim=True, unbiased=False)
    return (x - m) / torch.sqrt(v + eps)
def _scatter_add(tgt, idx, src, axis=0):
    return tgt.clone().index_add_(axis, idx, src)
def _segment_sum(src, seg, n):
    out = torch.zeros((n,) + src.shape[1:], dtype=src.dtype)
    return out.index_add_(0, seg, src)
def _pad(x, pw):
    flat = tuple(v for pair in reversed(pw) for v in pair)
    return torch.nn.functional.pad(x, flat)

kernel_name = 'concat_heads__sliding_local_dilated__grouped_kv_mqa__prompt'

def setup_inputs():

    _w = (lambda a: (lambda t: t.to(torch.bfloat16) if t.is_floating_point() else t)(torch.as_tensor(a)))
    def _A_setup():
        B, S, D = 1, 2048, 512
        return {
            "x": _w((lambda *s: torch.randn(*s, dtype=torch.bfloat16) * 0.1)(B, S, D)),
            "wqkv": _w((lambda *s: torch.randn(*s, dtype=torch.bfloat16) * 0.8)(D, 3 * D)),
            "wo": _w((lambda *s: torch.randn(*s, dtype=torch.bfloat16) * 0.8)(D, D)),
        }
    _A_in = _A_setup()

    def _B_setup():
        B, S, D, H = 1, 2048, 512, 32
        Dh = D // H
        return {
            "x": _w((lambda *s: torch.randn(*s, dtype=torch.bfloat16) * 0.05)(B, S, D)),
            "wq": _w((lambda *s: torch.randn(*s, dtype=torch.bfloat16) * 3.2)(D, H * Dh)),
            "wk": _w((lambda *s: torch.randn(*s, dtype=torch.bfloat16) * 3.2)(D, Dh)),
            "wv": _w((lambda *s: torch.randn(*s, dtype=torch.bfloat16) * 1.6)(D, Dh)),
            "wo": _w((lambda *s: torch.randn(*s, dtype=torch.bfloat16) * 1.6)(H * Dh, D)),
        }
    _B_in = _B_setup()

    return {
        "A_x": _A_in["x"],
        "A_wqkv": _A_in["wqkv"],
        "A_wo": _A_in["wo"],
        "B_x": _B_in["x"],
        "B_wq": _B_in["wq"],
        "B_wk": _B_in["wk"],
        "B_wv": _B_in["wv"],
        "B_wo": _B_in["wo"],
    }

def reference(A_x, A_wqkv, A_wo, B_x, B_wq, B_wk, B_wv, B_wo):
    def _A_ref(x, wqkv, wo):
        B, S, D = x.shape
        H = 32; Dh = D // H
        W, dil = 8, 2
        qkv = (lambda x, *d: x.permute(*d))((x @ wqkv).reshape(B, S, 3, H, Dh), 2, 0, 3, 1, 4)
        q, k, v = qkv[0], qkv[1], qkv[2]
        scale = Dh ** -0.5
        pos = torch.arange(S)
        off = torch.arange(W) * dil
        idx = pos[:, None] - off[None, :]
        mask = idx >= 0
        idx_c = torch.where(mask, idx, 0).reshape(-1)
        kg = k[:, :, idx_c, :].reshape(B, H, S, W, Dh)
        vg = v[:, :, idx_c, :].reshape(B, H, S, W, Dh)
        logits = torch.einsum("bhsd,bhswd->bhsw", q, kg) * scale
        logits = torch.where(mask[None, None, :, :], logits, -1e9)
        attn = _softmax(logits, axis=-1)
        o = torch.einsum("bhsw,bhswd->bhsd", attn, vg)
        return (lambda x, *d: x.permute(*d))(o, 0, 2, 1, 3).reshape(B, S, D) @ wo

    def _B_ref(x, wq, wk, wv, wo):
        B, S, D = x.shape
        H = 32
        Dh = D // H
        q = (lambda x, *d: x.permute(*d))((x @ wq).reshape(B, S, H, Dh), 0, 2, 1, 3)
        k = x @ wk
        v = x @ wv
        scores = torch.einsum("bhqd,bkd->bhqk", q, k) * (Dh ** -0.5)
        p = _softmax(scores, axis=-1)
        o = torch.einsum("bhqk,bkd->bhqd", p, v)
        return (lambda x, *d: x.permute(*d))(o, 0, 2, 1, 3).reshape(B, S, H * Dh) @ wo

    a = _A_ref(A_x, A_wqkv, A_wo)
    b = _B_ref(B_x, B_wq, B_wk, B_wv, B_wo)
    return torch.concatenate([a, b], axis=-1)
```

```asm
; @launch grid=(256,1,1) block=(768,1,1) lds=163840
.amdgcn_target "amdgcn-amd-amdhsa--gfx950"
.set CODE_BYTES, L_end - concat_heads__sliding_local_dilated__grouped_kv_mqa__prompt_kernel - 64
.text
.globl concat_heads__sliding_local_dilated__grouped_kv_mqa__prompt_kernel
.p2align 8
.type concat_heads__sliding_local_dilated__grouped_kv_mqa__prompt_kernel,@function
concat_heads__sliding_local_dilated__grouped_kv_mqa__prompt_kernel:
  s_cmp_ge_u32 s2, 256
  s_cbranch_scc1 L_end
  s_load_dwordx16 s[16:31], s[0:1], 0
  s_load_dwordx4 s[32:35], s[0:1], 64
  s_load_dwordx2 s[36:37], s[0:1], 80
  s_memrealtime s[76:77]
  s_getpc_b64 s[92:93]
  s_lshr_b32 s88, s2, 3
  s_mov_b32 s94, CODE_BYTES
  s_mov_b32 s95, 0x00020000
  v_lshlrev_b32 v166, 7, v0
  s_mul_i32 s6, s88, 896
  v_cmp_gt_u32 vcc, 7, v0
  v_lshrrev_b32 v1, 6, v0
  s_and_saveexec_b64 s[8:9], vcc
  s_cbranch_execz L_nocp
  buffer_load_dword v165, v166, s[92:95], s6 offen
L_nocp:
  s_mov_b64 exec, s[8:9]
  v_and_b32 v0, 63, v0
  v_readfirstlane_b32 s3, v1
  s_and_b32 s87, s2, 7
  s_lshl_b32 s5, s87, 2
  s_and_b32 s7, s88, 3
  s_add_u32 s5, s5, s7
  s_bfe_u32 s4, s88, 0x20002
  s_lshl_b32 s4, s4, 1
  s_lshr_b32 s7, s88, 4
  s_or_b32 s4, s4, s7
  v_lshlrev_b32 v1, 4, v0
  v_lshlrev_b32 v166, 7, v0
  v_mov_b32 v164, 0
  v_lshrrev_b32 v4, 4, v0
  v_and_b32 v5, 15, v0
  s_and_b32 s78, s3, 1
  s_bfe_u32 s79, s3, 0x10001
  s_and_b32 s86, s3, 3
  s_lshl_b32 s15, s86, 10
  s_and_b32 s80, s4, 1
  s_cmp_ge_u32 s87, 8
  s_cselect_b32 s80, 1, s80
  s_cmp_ge_u32 s3, 8
  s_cbranch_scc1 L_F
  v_lshrrev_b32 v8, 3, v0
  v_and_b32 v3, 7, v0
  s_lshl_b32 s6, s78, 2
  v_add_u32 v10, s6, v4
  v_xor_b32 v2, v3, v10
  v_lshlrev_b32 v2, 4, v2
  v_lshl_add_u32 v2, v8, 10, v2
  v_lshrrev_b32 v6, 2, v0
  v_and_b32 v6, 4, v6
  v_xor_b32 v3, v3, v6
  v_lshlrev_b32 v9, 4, v3
  v_lshl_add_u32 v3, v8, 10, v9
  s_cmp_ge_u32 s3, 4
  s_cbranch_scc1 L_P
  s_lshl_b32 s12, s5, 16
  s_lshl_b32 s6, s78, 13
  s_add_u32 s12, s12, s6
  s_lshl_b32 s6, s79, 9
  s_add_u32 s12, s12, s6
  s_lshl_b32 s13, s79, 15
  s_lshl_b32 s6, s78, 10
  s_add_u32 s13, s13, s6
  s_and_b32 s14, s4, 6
  s_lshl_b32 s38, s3, 12
  s_waitcnt lgkmcnt(0)
  s_mov_b64 s[64:65], s[34:35]
  s_mov_b32 s66, 256
  s_mov_b32 s67, 0x00020000
  s_or_b32 s6, s2, s3
  s_cmp_lg_u32 s6, 0
  s_cbranch_scc1 L_nononce
  s_lshl_b32 s76, s76, 4
  s_or_b32 s76, s76, 16
  v_mov_b32 v10, s76
  s_mov_b64 exec, 1
  buffer_store_dword v10, v164, s[64:67], 0 offen sc1
  s_mov_b64 exec, -1
L_nononce:
  s_mov_b64 s[48:49], s[22:23]
  s_mov_b32 s50, 2097152
  s_mov_b32 s51, 0x00020000
  s_bitcmp1_b32 s4, 0
  s_cbranch_scc1 L_dodd
  s_lshl_b32 s6, s14, 13
  s_add_u32 s6, s6, s12
  s_lshl_b32 s7, s14, 10
  s_add_u32 s7, s7, s13
  s_add_u32 m0, s7, 0
  s_nop 0
  buffer_load_dwordx4 v2, s[48:51], s6 offen offset:0 lds
  s_add_u32 m0, s7, 8064
  s_nop 0
  buffer_load_dwordx4 v2, s[48:51], s6 offen offset:128 lds
  s_add_u32 m0, s7, 16128
  s_nop 0
  buffer_load_dwordx4 v2, s[48:51], s6 offen offset:256 lds
  s_add_u32 m0, s7, 24192
  s_nop 0
  buffer_load_dwordx4 v2, s[48:51], s6 offen offset:384 lds
  s_add_u32 s14, s14, 2
  s_and_b32 s14, s14, 6
  s_mov_b64 s[56:57], s[26:27]
  s_mov_b32 s58, 16384
  s_mov_b32 s59, 0x00020000
  s_mov_b64 s[40:41], s[28:29]
  s_mov_b32 s42, 16384
  s_mov_b32 s43, 0x00020000
  s_add_u32 m0, s38, 131072
  s_nop 0
  buffer_load_dwordx4 v1, s[56:59], s38 offen offset:0 lds
  buffer_load_dwordx4 v1, s[56:59], s38 offen offset:1024 lds
  buffer_load_dwordx4 v1, s[56:59], s38 offen offset:2048 lds
  buffer_load_dwordx4 v1, s[56:59], s38 offen offset:3072 lds
  s_add_u32 m0, s38, 147456
  s_nop 0
  buffer_load_dwordx4 v1, s[40:43], s38 offen offset:0 lds
  buffer_load_dwordx4 v1, s[40:43], s38 offen offset:1024 lds
  buffer_load_dwordx4 v1, s[40:43], s38 offen offset:2048 lds
  buffer_load_dwordx4 v1, s[40:43], s38 offen offset:3072 lds
  s_mov_b32 s85, 3
  s_branch L_dx
L_dodd:
  s_lshr_b32 s6, s4, 1
  s_lshl_b32 s6, s6, 2
  s_and_b32 s7, s88, 3
  s_add_u32 s39, s6, s7
  s_cmp_lt_u32 s3, 2
  s_cselect_b64 s[56:57], s[26:27], s[28:29]
  s_mov_b32 s58, 16384
  s_mov_b32 s59, 0x00020000
  s_lshl_b32 s6, s39, 10
  s_lshl_b32 s7, s78, 9
  s_add_u32 s6, s6, s7
  s_mov_b64 exec, 0xf
  buffer_load_dword v165, v166, s[56:59], s6 offen
  s_mov_b64 exec, -1
  s_mov_b64 s[52:53], s[24:25]
  s_mov_b32 s54, 524288
  s_mov_b32 s55, 0x00020000
  s_lshl_b32 s6, s39, 15
  s_lshl_b32 s7, s3, 13
  s_add_u32 s6, s6, s7
  s_waitcnt vmcnt(0)
  buffer_load_dword v165, v166, s[52:55], s6 offen
  s_mov_b32 s85, 4
L_dx:
  s_lshl_b32 s6, s14, 13
  s_add_u32 s6, s6, s12
  s_lshl_b32 s7, s14, 10
  s_add_u32 s7, s7, s13
  s_add_u32 m0, s7, 0
  s_nop 0
  buffer_load_dwordx4 v2, s[48:51], s6 offen offset:0 lds
  s_add_u32 m0, s7, 8064
  s_nop 0
  buffer_load_dwordx4 v2, s[48:51], s6 offen offset:128 lds
  s_add_u32 m0, s7, 16128
  s_nop 0
  buffer_load_dwordx4 v2, s[48:51], s6 offen offset:256 lds
  s_add_u32 m0, s7, 24192
  s_nop 0
  buffer_load_dwordx4 v2, s[48:51], s6 offen offset:384 lds
  s_add_u32 s14, s14, 2
  s_and_b32 s14, s14, 6
  s_sub_u32 s85, s85, 1
  s_cmp_lg_u32 s85, 0
  s_cbranch_scc1 L_dx
  s_mov_b64 s[52:53], s[24:25]
  s_mov_b32 s54, 524288
  s_mov_b32 s55, 0x00020000
  s_bitcmp1_b32 s4, 0
  s_cbranch_scc1 L_dw
  s_waitcnt vmcnt(12)
  s_barrier
L_dw:
  s_mov_b64 s[60:61], s[36:37]
  s_mov_b32 s62, 8388608
  s_mov_b32 s63, 0x00020000
  s_mov_b64 s[68:69], s[32:33]
  s_mov_b32 s70, 4194304
  s_mov_b32 s71, 0x00020000
  s_lshl_b32 s77, s5, 3
  s_add_u32 s77, s77, s4
  s_lshl_b32 s82, s5, 1
  s_add_u32 s82, s82, s79
  s_lshl_b32 s83, s82, 16
  s_lshl_b32 s82, s82, 15
  s_lshl_b32 s7, s4, 7
  s_add_u32 s83, s83, s7
  s_lshl_b32 s6, s78, 6
  s_add_u32 s83, s83, s6
  s_lshl_b32 s12, s86, 13
  s_add_u32 s12, s12, s7
  v_lshrrev_b32 v13, 5, v0
  v_bfe_u32 v14, v0, 2, 2
  v_lshl_add_u32 v12, v13, 2, v14
  v_lshlrev_b32 v12, 7, v12
  v_and_b32 v14, 2, v14
  v_bfe_u32 v13, v0, 4, 1
  v_xor_b32 v14, v14, v13
  v_lshl_add_u32 v12, v14, 5, v12
  v_and_b32 v14, 3, v0
  v_lshl_add_u32 v12, v14, 3, v12
  s_lshl_b32 s6, s78, 6
  v_xor_b32 v12, s6, v12
  v_add_u32 v8, 133120, v1
  v_lshlrev_b32 v11, 4, v5
  v_lshrrev_b32 v13, 5, v0
  v_lshl_add_u32 v11, v13, 8, v11
  v_add_u32 v9, 134144, v11
  v_mov_b64 v[88:89], 0
  v_mov_b64 v[90:91], 0
  v_mov_b64 v[92:93], 0
  v_mov_b64 v[94:95], 0
  v_mov_b64 v[96:97], 0
  v_mov_b64 v[98:99], 0
  v_mov_b64 v[100:101], 0
  v_mov_b64 v[102:103], 0
  v_mov_b64 v[104:105], 0
  v_mov_b64 v[106:107], 0
  v_mov_b64 v[108:109], 0
  v_mov_b64 v[110:111], 0
  v_mov_b64 v[112:113], 0
  v_mov_b64 v[114:115], 0
  v_mov_b64 v[116:117], 0
  v_mov_b64 v[118:119], 0
  v_mov_b64 v[124:125], 0
  v_mov_b64 v[126:127], 0
  v_mov_b64 v[132:133], 0
  v_mov_b64 v[134:135], 0
  v_mov_b64 v[136:137], 0
  v_mov_b64 v[138:139], 0
  v_mov_b64 v[144:145], 0
  v_mov_b64 v[146:147], 0
  v_mov_b64 v[148:149], 0
  v_mov_b64 v[150:151], 0
  v_mov_b64 v[156:157], 0
  v_mov_b64 v[158:159], 0
  v_mov_b64 v[160:161], 0
  v_mov_b64 v[162:163], 0
  s_mov_b32 exec_lo, 0x110000
  s_mov_b32 exec_hi, 0x110000
  v_mov_b32 v14, 0x3f803f80
  v_mov_b32 v15, v14
  v_mov_b64 v[132:133], v[14:15]
  v_mov_b64 v[134:135], v[14:15]
  v_mov_b64 v[136:137], v[14:15]
  v_mov_b64 v[138:139], v[14:15]
  v_mov_b64 v[144:145], v[14:15]
  v_mov_b64 v[146:147], v[14:15]
  v_mov_b64 v[148:149], v[14:15]
  v_mov_b64 v[150:151], v[14:15]
  v_mov_b64 v[156:157], v[14:15]
  v_mov_b64 v[158:159], v[14:15]
  v_mov_b64 v[160:161], v[14:15]
  v_mov_b64 v[162:163], v[14:15]
  s_mov_b64 exec, -1
  s_mov_b32 s92, 0xffff
  s_mov_b32 s93, 0xffff
  s_lshl_b32 s6, s86, 11
  s_add_u32 s6, s6, 0
  v_add_u32 v13, s6, v1
  v_mov_b64 v[6:7], 0
  s_lshl_b32 s6, s86, 12
  s_add_u32 s6, s6, 98304
  v_add_u32 v2, s6, v1
  v_and_b32 v10, 31, v0
  s_lshl_b32 s6, s86, 8
  s_add_u32 s6, s6, 114688
  v_lshl_add_u32 v10, v10, 2, s6
  s_cmp_lg_u32 s80, 0
  s_cbranch_scc1 L_dw2
  s_barrier
L_dw2:
  s_add_u32 m0, s15, 65536
  s_add_u32 s6, s12, 0
  buffer_load_dwordx4 v3, s[52:55], s6 offen lds
  s_add_u32 m0, s15, 69632
  s_add_u32 s6, s12, 32768
  buffer_load_dwordx4 v3, s[52:55], s6 offen lds
  s_add_u32 m0, s15, 73728
  s_add_u32 s6, s12, 65536
  buffer_load_dwordx4 v3, s[52:55], s6 offen lds
  s_add_u32 m0, s15, 77824
  s_add_u32 s6, s12, 98304
  buffer_load_dwordx4 v3, s[52:55], s6 offen lds
  s_add_u32 m0, s15, 81920
  s_add_u32 s6, s12, 131072
  buffer_load_dwordx4 v3, s[52:55], s6 offen lds
  s_add_u32 m0, s15, 86016
  s_add_u32 s6, s12, 163840
  buffer_load_dwordx4 v3, s[52:55], s6 offen lds
  s_add_u32 m0, s15, 90112
  s_add_u32 s6, s12, 196608
  buffer_load_dwordx4 v3, s[52:55], s6 offen lds
  s_add_u32 m0, s15, 94208
  s_add_u32 s6, s12, 229376
  buffer_load_dwordx4 v3, s[52:55], s6 offen lds
  s_add_u32 m0, s15, 98304
  s_add_u32 s6, s12, 262144
  buffer_load_dwordx4 v3, s[52:55], s6 offen lds
  s_add_u32 m0, s15, 102400
  s_add_u32 s6, s12, 294912
  buffer_load_dwordx4 v3, s[52:55], s6 offen lds
  s_add_u32 m0, s15, 106496
  s_add_u32 s6, s12, 327680
  buffer_load_dwordx4 v3, s[52:55], s6 offen lds
  s_add_u32 m0, s15, 110592
  s_add_u32 s6, s12, 360448
  buffer_load_dwordx4 v3, s[52:55], s6 offen lds
  s_add_u32 m0, s15, 114688
  s_add_u32 s6, s12, 393216
  buffer_load_dwordx4 v3, s[52:55], s6 offen lds
  s_add_u32 m0, s15, 118784
  s_add_u32 s6, s12, 425984
  buffer_load_dwordx4 v3, s[52:55], s6 offen lds
  s_add_u32 m0, s15, 122880
  s_add_u32 s6, s12, 458752
  buffer_load_dwordx4 v3, s[52:55], s6 offen lds
  s_add_u32 m0, s15, 126976
  s_add_u32 s6, s12, 491520
  buffer_load_dwordx4 v3, s[52:55], s6 offen lds
  s_mov_b32 s84, 524288
  s_waitcnt vmcnt(14)
  s_barrier
  s_waitcnt vmcnt(10)
  s_barrier
  s_cmp_lg_u32 s3, 3
  s_cbranch_scc1 L_dnp
  buffer_load_dword v165, v164, s[64:67], 0 offen sc1
  s_mov_b64 exec, 0xfffffff
  s_waitcnt vmcnt(5)
  s_barrier
  buffer_load_dword v24, v166, s[60:63], s84 offen sc1
  s_waitcnt vmcnt(2)
  s_barrier
  s_waitcnt vmcnt(0)
  v_cmp_eq_u32 vcc, 0, v165
  s_nop 4
  s_cbranch_vccz L_nd_x
  s_mov_b32 s7, 0
L_nd:
  buffer_load_dword v165, v164, s[64:67], 0 offen sc1
  s_waitcnt vmcnt(0)
  v_cmp_eq_u32 vcc, 0, v165
  s_add_u32 s7, s7, 1
  s_cmp_ge_u32 s7, 1048576
  s_cbranch_scc1 L_nd_x
  s_nop 1
  s_cbranch_vccnz L_nd
L_nd_x:
  v_readfirstlane_b32 s76, v165
  s_mov_b32 s7, 0
L_kvp:
  s_nop 0
  v_cmp_ne_u32 vcc, s76, v24
  s_add_u32 s7, s7, 1
  s_cmp_ge_u32 s7, 1048576
  s_cbranch_scc1 L_kvp_x
  s_nop 2
  s_cbranch_vccz L_kvp_x
  s_mov_b64 exec, vcc
  buffer_load_dword v24, v166, s[60:63], s84 offen sc1
  s_waitcnt vmcnt(0)
  s_branch L_kvp
L_kvp_x:
  s_mov_b64 exec, -1
  s_mov_b32 m0, 133120
  s_mov_b32 s6, 0
L_ekv:
  buffer_load_dwordx4 v1, s[60:63], s6 offen offset:0 sc1 lds
  buffer_load_dwordx4 v1, s[60:63], s6 offen offset:1024 sc1 lds
  buffer_load_dwordx4 v1, s[60:63], s6 offen offset:2048 sc1 lds
  buffer_load_dwordx4 v1, s[60:63], s6 offen offset:3072 sc1 lds
  s_add_u32 m0, m0, 4096
  s_add_u32 s6, s6, 4096
  s_cmp_lt_u32 s6, 28672
  s_cbranch_scc1 L_ekv
  s_waitcnt vmcnt(22)
  s_branch L_dbe
L_dnp:
  s_waitcnt vmcnt(4)
  s_barrier
  s_waitcnt vmcnt(0)
  s_barrier
L_dbe:
  s_setprio 1
  s_barrier
  ds_read_b128 v[16:19], v13
  ds_read_b128 v[20:23], v13 offset:1024
  ds_read_b128 v[128:131], v8 offset:0
  s_mov_b64 exec, s[92:93]
  ds_read_b128 v[132:135], v9 offset:0
  ds_read_b128 v[136:139], v9 offset:512
  s_mov_b64 exec, -1
  ds_read_b128 v[140:143], v8 offset:2048
  s_mov_b64 exec, s[92:93]
  ds_read_b128 v[144:147], v9 offset:2048
  ds_read_b128 v[148:151], v9 offset:2560
  s_mov_b64 exec, -1
  s_waitcnt lgkmcnt(5)
  v_mfma_f32_32x32x16_bf16 v[24:39], v[128:131], v[16:19], 0
  v_mfma_f32_32x32x16_bf16 v[40:55], v[128:131], v[20:23], 0
  s_mov_b32 s85, 0
  s_mov_b32 s84, 22528
  s_movk_i32 s91, 60
  s_nop 7
  v_max3_f32 v56, v24, v25, v26
  v_max3_f32 v56, v56, v27, v28
  v_max3_f32 v56, v56, v29, v30
  v_max3_f32 v56, v56, v31, v32
  v_max3_f32 v56, v56, v33, v34
  v_max3_f32 v56, v56, v35, v36
  v_max3_f32 v56, v56, v37, v38
  v_max_f32 v56, v56, v39
  v_mov_b32 v57, v56
  v_max3_f32 v72, v40, v41, v42
  v_max3_f32 v72, v72, v43, v44
  v_max3_f32 v72, v72, v45, v46
  v_max3_f32 v72, v72, v47, v48
  v_max3_f32 v72, v72, v49, v50
  v_max3_f32 v72, v72, v51, v52
  v_max3_f32 v72, v72, v53, v54
  v_max_f32 v72, v72, v55
  v_mov_b32 v73, v72
  v_permlane32_swap_b32 v56, v57
  s_nop 0
  v_permlane32_swap_b32 v72, v73
  v_max_f32 v56, v56, v57
  v_sub_f32 v56, 0xc2be0000, v56
  v_mov_b32 v57, v56
  v_max_f32 v72, v72, v73
  v_sub_f32 v72, 0xc2be0000, v72
  v_mov_b32 v73, v72
  v_pk_add_f32 v[24:25], v[24:25], v[56:57]
  v_pk_add_f32 v[26:27], v[26:27], v[56:57]
  v_pk_add_f32 v[28:29], v[28:29], v[56:57]
  v_pk_add_f32 v[30:31], v[30:31], v[56:57]
  v_pk_add_f32 v[32:33], v[32:33], v[56:57]
  v_pk_add_f32 v[34:35], v[34:35], v[56:57]
  v_pk_add_f32 v[36:37], v[36:37], v[56:57]
  v_pk_add_f32 v[38:39], v[38:39], v[56:57]
  v_mov_b64 v[74:75], v[72:73]
  v_mov_b64 v[76:77], v[72:73]
  v_mov_b64 v[78:79], v[72:73]
  v_mov_b64 v[80:81], v[72:73]
  v_mov_b64 v[82:83], v[72:73]
  v_mov_b64 v[84:85], v[72:73]
  v_mov_b64 v[86:87], v[72:73]
  v_mov_b64 v[58:59], v[56:57]
  v_mov_b64 v[60:61], v[56:57]
  v_mov_b64 v[62:63], v[56:57]
  v_mov_b64 v[64:65], v[56:57]
  v_mov_b64 v[66:67], v[56:57]
  v_mov_b64 v[68:69], v[56:57]
  v_mov_b64 v[70:71], v[56:57]
  v_mov_b64 v[54:55], 0
  s_waitcnt lgkmcnt(0)
  v_exp_f32 v24, v24
  v_cvt_pk_bf16_f32 v127, v54, v55
  v_mfma_f32_32x32x16_bf16 v[40:55], v[128:131], v[20:23], v[72:87]
  v_exp_f32 v25, v25
  v_exp_f32 v26, v26
  v_cvt_pk_bf16_f32 v120, v24, v25
  v_exp_f32 v27, v27
  v_exp_f32 v28, v28
  v_cvt_pk_bf16_f32 v121, v26, v27
  v_mfma_f32_32x32x16_bf16 v[104:119], v[160:163], v[124:127], v[104:119]
  v_exp_f32 v29, v29
  v_exp_f32 v30, v30
  v_cvt_pk_bf16_f32 v122, v28, v29
  v_exp_f32 v31, v31
  v_exp_f32 v32, v32
  v_cvt_pk_bf16_f32 v123, v30, v31
  v_exp_f32 v33, v33
  v_exp_f32 v34, v34
  v_mfma_f32_32x32x16_bf16 v[88:103], v[132:135], v[120:123], v[88:103]
  v_cvt_pk_bf16_f32 v124, v32, v33
  v_exp_f32 v35, v35
  v_exp_f32 v36, v36
  v_cvt_pk_bf16_f32 v125, v34, v35
  v_exp_f32 v37, v37
  v_exp_f32 v38, v38
  v_cvt_pk_bf16_f32 v126, v36, v37
  v_exp_f32 v39, v39
  v_exp_f32 v40, v40
  v_cvt_pk_bf16_f32 v127, v38, v39
  s_waitcnt lgkmcnt(0)
  v_mfma_f32_32x32x16_bf16 v[24:39], v[140:143], v[16:19], v[56:71]
  v_exp_f32 v41, v41
  v_exp_f32 v42, v42
  v_cvt_pk_bf16_f32 v120, v40, v41
  v_exp_f32 v43, v43
  v_exp_f32 v44, v44
  v_cvt_pk_bf16_f32 v121, v42, v43
  v_mfma_f32_32x32x16_bf16 v[88:103], v[136:139], v[124:127], v[88:103]
  ds_read_b128 v[152:155], v8 offset:4096
  s_mov_b64 exec, s[92:93]
  ds_read_b128 v[156:159], v9 offset:4096
  ds_read_b128 v[160:163], v9 offset:4608
  s_mov_b64 exec, -1
  v_add_u32 v8, 6144, v8
  v_add_u32 v9, 6144, v9
  v_exp_f32 v45, v45
  v_exp_f32 v46, v46
  v_cvt_pk_bf16_f32 v122, v44, v45
  v_exp_f32 v47, v47
  v_exp_f32 v48, v48
  v_cvt_pk_bf16_f32 v123, v46, v47
  v_exp_f32 v49, v49
  v_exp_f32 v50, v50
  v_mfma_f32_32x32x16_bf16 v[104:119], v[132:135], v[120:123], v[104:119]
  v_cvt_pk_bf16_f32 v124, v48, v49
  v_exp_f32 v51, v51
  v_exp_f32 v52, v52
  v_cvt_pk_bf16_f32 v125, v50, v51
  v_exp_f32 v53, v53
  v_exp_f32 v54, v54
  v_cvt_pk_bf16_f32 v126, v52, v53
  v_exp_f32 v55, v55
  s_waitcnt vmcnt(0)
  .p2align 6
L_dloop:
  s_waitcnt lgkmcnt(0)
  s_barrier
  v_exp_f32 v24, v24
  v_cvt_pk_bf16_f32 v127, v54, v55
  v_mfma_f32_32x32x16_bf16 v[40:55], v[140:143], v[20:23], v[72:87]
  v_exp_f32 v25, v25
  v_exp_f32 v26, v26
  v_cvt_pk_bf16_f32 v120, v24, v25
  v_exp_f32 v27, v27
  v_exp_f32 v28, v28
  v_cvt_pk_bf16_f32 v121, v26, v27
  v_mfma_f32_32x32x16_bf16 v[104:119], v[136:139], v[124:127], v[104:119]
  v_exp_f32 v29, v29
  v_exp_f32 v30, v30
  v_cvt_pk_bf16_f32 v122, v28, v29
  v_exp_f32 v31, v31
  v_exp_f32 v32, v32
  v_cvt_pk_bf16_f32 v123, v30, v31
  v_exp_f32 v33, v33
  v_exp_f32 v34, v34
  v_mfma_f32_32x32x16_bf16 v[88:103], v[144:147], v[120:123], v[88:103]
  v_cvt_pk_bf16_f32 v124, v32, v33
  v_exp_f32 v35, v35
  v_exp_f32 v36, v36
  v_cvt_pk_bf16_f32 v125, v34, v35
  v_exp_f32 v37, v37
  v_exp_f32 v38, v38
  v_cvt_pk_bf16_f32 v126, v36, v37
  v_exp_f32 v39, v39
  v_exp_f32 v40, v40
  v_cvt_pk_bf16_f32 v127, v38, v39
  s_waitcnt lgkmcnt(0)
  v_mfma_f32_32x32x16_bf16 v[24:39], v[152:155], v[16:19], v[56:71]
  v_exp_f32 v41, v41
  v_exp_f32 v42, v42
  v_cvt_pk_bf16_f32 v120, v40, v41
  v_exp_f32 v43, v43
  v_exp_f32 v44, v44
  v_cvt_pk_bf16_f32 v121, v42, v43
  v_mfma_f32_32x32x16_bf16 v[88:103], v[148:151], v[124:127], v[88:103]
  ds_read_b128 v[128:131], v8 offset:0
  s_mov_b64 exec, s[92:93]
  ds_read_b128 v[132:135], v9 offset:0
  ds_read_b128 v[136:139], v9 offset:512
  s_mov_b64 exec, -1
  s_add_u32 s85, s85, 1
  s_sub_u32 s84, 0, s84
  v_exp_f32 v45, v45
  v_exp_f32 v46, v46
  v_cvt_pk_bf16_f32 v122, v44, v45
  v_exp_f32 v47, v47
  v_exp_f32 v48, v48
  v_cvt_pk_bf16_f32 v123, v46, v47
  v_exp_f32 v49, v49
  v_exp_f32 v50, v50
  v_mfma_f32_32x32x16_bf16 v[104:119], v[144:147], v[120:123], v[104:119]
  v_cvt_pk_bf16_f32 v124, v48, v49
  v_exp_f32 v51, v51
  v_exp_f32 v52, v52
  v_cvt_pk_bf16_f32 v125, v50, v51
  v_exp_f32 v53, v53
  v_exp_f32 v54, v54
  v_cvt_pk_bf16_f32 v126, v52, v53
  v_exp_f32 v55, v55
  v_exp_f32 v24, v24
  v_cvt_pk_bf16_f32 v127, v54, v55
  v_mfma_f32_32x32x16_bf16 v[40:55], v[152:155], v[20:23], v[72:87]
  v_exp_f32 v25, v25
  v_exp_f32 v26, v26
  v_cvt_pk_bf16_f32 v120, v24, v25
  v_exp_f32 v27, v27
  v_exp_f32 v28, v28
  v_cvt_pk_bf16_f32 v121, v26, v27
  v_mfma_f32_32x32x16_bf16 v[104:119], v[148:151], v[124:127], v[104:119]
  v_exp_f32 v29, v29
  v_exp_f32 v30, v30
  v_cvt_pk_bf16_f32 v122, v28, v29
  v_exp_f32 v31, v31
  v_exp_f32 v32, v32
  v_cvt_pk_bf16_f32 v123, v30, v31
  v_exp_f32 v33, v33
  v_exp_f32 v34, v34
  v_mfma_f32_32x32x16_bf16 v[88:103], v[156:159], v[120:123], v[88:103]
  v_cvt_pk_bf16_f32 v124, v32, v33
  v_exp_f32 v35, v35
  v_exp_f32 v36, v36
  v_cvt_pk_bf16_f32 v125, v34, v35
  v_exp_f32 v37, v37
  v_exp_f32 v38, v38
  v_cvt_pk_bf16_f32 v126, v36, v37
  v_exp_f32 v39, v39
  v_exp_f32 v40, v40
  v_cvt_pk_bf16_f32 v127, v38, v39
  s_waitcnt lgkmcnt(0)
  v_mfma_f32_32x32x16_bf16 v[24:39], v[128:131], v[16:19], v[56:71]
  v_exp_f32 v41, v41
  v_exp_f32 v42, v42
  v_cvt_pk_bf16_f32 v120, v40, v41
  v_exp_f32 v43, v43
  v_exp_f32 v44, v44
  v_cvt_pk_bf16_f32 v121, v42, v43
  v_mfma_f32_32x32x16_bf16 v[88:103], v[160:163], v[124:127], v[88:103]
  ds_read_b128 v[140:143], v8 offset:2048
  s_mov_b64 exec, s[92:93]
  ds_read_b128 v[144:147], v9 offset:2048
  ds_read_b128 v[148:151], v9 offset:2560
  s_mov_b64 exec, -1
  v_exp_f32 v45, v45
  v_exp_f32 v46, v46
  v_cvt_pk_bf16_f32 v122, v44, v45
  v_exp_f32 v47, v47
  v_exp_f32 v48, v48
  v_cvt_pk_bf16_f32 v123, v46, v47
  v_exp_f32 v49, v49
  v_exp_f32 v50, v50
  v_mfma_f32_32x32x16_bf16 v[104:119], v[156:159], v[120:123], v[104:119]
  v_cvt_pk_bf16_f32 v124, v48, v49
  v_exp_f32 v51, v51
  v_exp_f32 v52, v52
  v_cvt_pk_bf16_f32 v125, v50, v51
  v_exp_f32 v53, v53
  v_exp_f32 v54, v54
  v_cvt_pk_bf16_f32 v126, v52, v53
  v_exp_f32 v55, v55
  v_exp_f32 v24, v24
  v_cvt_pk_bf16_f32 v127, v54, v55
  v_mfma_f32_32x32x16_bf16 v[40:55], v[128:131], v[20:23], v[72:87]
  v_exp_f32 v25, v25
  v_exp_f32 v26, v26
  v_cvt_pk_bf16_f32 v120, v24, v25
  v_exp_f32 v27, v27
  v_exp_f32 v28, v28
  v_cvt_pk_bf16_f32 v121, v26, v27
  v_mfma_f32_32x32x16_bf16 v[104:119], v[160:163], v[124:127], v[104:119]
  v_exp_f32 v29, v29
  v_exp_f32 v30, v30
  v_cvt_pk_bf16_f32 v122, v28, v29
  v_exp_f32 v31, v31
  v_exp_f32 v32, v32
  v_cvt_pk_bf16_f32 v123, v30, v31
  v_exp_f32 v33, v33
  v_exp_f32 v34, v34
  v_mfma_f32_32x32x16_bf16 v[88:103], v[132:135], v[120:123], v[88:103]
  v_cvt_pk_bf16_f32 v124, v32, v33
  v_exp_f32 v35, v35
  v_exp_f32 v36, v36
  v_cvt_pk_bf16_f32 v125, v34, v35
  v_exp_f32 v37, v37
  v_exp_f32 v38, v38
  v_cvt_pk_bf16_f32 v126, v36, v37
  v_exp_f32 v39, v39
  v_exp_f32 v40, v40
  v_cvt_pk_bf16_f32 v127, v38, v39
  s_waitcnt lgkmcnt(0)
  v_mfma_f32_32x32x16_bf16 v[24:39], v[140:143], v[16:19], v[56:71]
  v_exp_f32 v41, v41
  v_exp_f32 v42, v42
  v_cvt_pk_bf16_f32 v120, v40, v41
  v_exp_f32 v43, v43
  v_exp_f32 v44, v44
  v_cvt_pk_bf16_f32 v121, v42, v43
  v_mfma_f32_32x32x16_bf16 v[88:103], v[136:139], v[124:127], v[88:103]
  ds_read_b128 v[152:155], v8 offset:4096
  s_mov_b64 exec, s[92:93]
  ds_read_b128 v[156:159], v9 offset:4096
  ds_read_b128 v[160:163], v9 offset:4608
  s_mov_b64 exec, -1
  v_exp_f32 v45, v45
  v_exp_f32 v46, v46
  v_cvt_pk_bf16_f32 v122, v44, v45
  v_exp_f32 v47, v47
  v_exp_f32 v48, v48
  v_cvt_pk_bf16_f32 v123, v46, v47
  v_exp_f32 v49, v49
  v_exp_f32 v50, v50
  v_mfma_f32_32x32x16_bf16 v[104:119], v[132:135], v[120:123], v[104:119]
  v_cvt_pk_bf16_f32 v124, v48, v49
  v_exp_f32 v51, v51
  v_exp_f32 v52, v52
  v_cvt_pk_bf16_f32 v125, v50, v51
  v_exp_f32 v53, v53
  v_exp_f32 v54, v54
  v_cvt_pk_bf16_f32 v126, v52, v53
  v_exp_f32 v55, v55
  v_exp_f32 v24, v24
  v_cvt_pk_bf16_f32 v127, v54, v55
  v_mfma_f32_32x32x16_bf16 v[40:55], v[140:143], v[20:23], v[72:87]
  v_exp_f32 v25, v25
  v_exp_f32 v26, v26
  v_cvt_pk_bf16_f32 v120, v24, v25
  v_exp_f32 v27, v27
  v_exp_f32 v28, v28
  v_cvt_pk_bf16_f32 v121, v26, v27
  v_mfma_f32_32x32x16_bf16 v[104:119], v[136:139], v[124:127], v[104:119]
  v_exp_f32 v29, v29
  v_exp_f32 v30, v30
  v_cvt_pk_bf16_f32 v122, v28, v29
  v_exp_f32 v31, v31
  v_exp_f32 v32, v32
  v_cvt_pk_bf16_f32 v123, v30, v31
  v_exp_f32 v33, v33
  v_exp_f32 v34, v34
  v_mfma_f32_32x32x16_bf16 v[88:103], v[144:147], v[120:123], v[88:103]
  v_cvt_pk_bf16_f32 v124, v32, v33
  v_exp_f32 v35, v35
  v_exp_f32 v36, v36
  v_cvt_pk_bf16_f32 v125, v34, v35
  v_exp_f32 v37, v37
  v_exp_f32 v38, v38
  v_cvt_pk_bf16_f32 v126, v36, v37
  v_exp_f32 v39, v39
  v_exp_f32 v40, v40
  v_cvt_pk_bf16_f32 v127, v38, v39
  s_waitcnt lgkmcnt(0)
  v_mfma_f32_32x32x16_bf16 v[24:39], v[152:155], v[16:19], v[56:71]
  v_exp_f32 v41, v41
  v_exp_f32 v42, v42
  v_cvt_pk_bf16_f32 v120, v40, v41
  v_exp_f32 v43, v43
  v_exp_f32 v44, v44
  v_cvt_pk_bf16_f32 v121, v42, v43
  v_mfma_f32_32x32x16_bf16 v[88:103], v[148:151], v[124:127], v[88:103]
  ds_read_b128 v[128:131], v8 offset:6144
  s_mov_b64 exec, s[92:93]
  ds_read_b128 v[132:135], v9 offset:6144
  ds_read_b128 v[136:139], v9 offset:6656
  s_mov_b64 exec, -1
  v_exp_f32 v45, v45
  v_exp_f32 v46, v46
  v_cvt_pk_bf16_f32 v122, v44, v45
  v_exp_f32 v47, v47
  v_exp_f32 v48, v48
  v_cvt_pk_bf16_f32 v123, v46, v47
  v_exp_f32 v49, v49
  v_exp_f32 v50, v50
  v_mfma_f32_32x32x16_bf16 v[104:119], v[144:147], v[120:123], v[104:119]
  v_cvt_pk_bf16_f32 v124, v48, v49
  v_exp_f32 v51, v51
  v_exp_f32 v52, v52
  v_cvt_pk_bf16_f32 v125, v50, v51
  v_exp_f32 v53, v53
  v_exp_f32 v54, v54
  v_cvt_pk_bf16_f32 v126, v52, v53
  v_exp_f32 v55, v55
  v_exp_f32 v24, v24
  v_cvt_pk_bf16_f32 v127, v54, v55
  v_mfma_f32_32x32x16_bf16 v[40:55], v[152:155], v[20:23], v[72:87]
  v_exp_f32 v25, v25
  v_exp_f32 v26, v26
  v_cvt_pk_bf16_f32 v120, v24, v25
  v_exp_f32 v27, v27
  v_exp_f32 v28, v28
  v_cvt_pk_bf16_f32 v121, v26, v27
  v_mfma_f32_32x32x16_bf16 v[104:119], v[148:151], v[124:127], v[104:119]
  v_exp_f32 v29, v29
  v_exp_f32 v30, v30
  v_cvt_pk_bf16_f32 v122, v28, v29
  v_exp_f32 v31, v31
  v_exp_f32 v32, v32
  v_cvt_pk_bf16_f32 v123, v30, v31
  v_exp_f32 v33, v33
  v_exp_f32 v34, v34
  v_mfma_f32_32x32x16_bf16 v[88:103], v[156:159], v[120:123], v[88:103]
  v_cvt_pk_bf16_f32 v124, v32, v33
  v_exp_f32 v35, v35
  v_exp_f32 v36, v36
  v_cvt_pk_bf16_f32 v125, v34, v35
  v_exp_f32 v37, v37
  v_exp_f32 v38, v38
  v_cvt_pk_bf16_f32 v126, v36, v37
  v_exp_f32 v39, v39
  v_exp_f32 v40, v40
  v_cvt_pk_bf16_f32 v127, v38, v39
  s_waitcnt lgkmcnt(0)
  v_mfma_f32_32x32x16_bf16 v[24:39], v[128:131], v[16:19], v[56:71]
  v_exp_f32 v41, v41
  v_exp_f32 v42, v42
  v_cvt_pk_bf16_f32 v120, v40, v41
  v_exp_f32 v43, v43
  v_exp_f32 v44, v44
  v_cvt_pk_bf16_f32 v121, v42, v43
  v_mfma_f32_32x32x16_bf16 v[88:103], v[160:163], v[124:127], v[88:103]
  ds_read_b128 v[140:143], v8 offset:8192
  s_mov_b64 exec, s[92:93]
  ds_read_b128 v[144:147], v9 offset:8192
  ds_read_b128 v[148:151], v9 offset:8704
  s_mov_b64 exec, -1
  v_exp_f32 v45, v45
  v_exp_f32 v46, v46
  v_cvt_pk_bf16_f32 v122, v44, v45
  v_exp_f32 v47, v47
  v_exp_f32 v48, v48
  v_cvt_pk_bf16_f32 v123, v46, v47
  v_exp_f32 v49, v49
  v_exp_f32 v50, v50
  v_mfma_f32_32x32x16_bf16 v[104:119], v[156:159], v[120:123], v[104:119]
  v_cvt_pk_bf16_f32 v124, v48, v49
  v_exp_f32 v51, v51
  v_exp_f32 v52, v52
  v_cvt_pk_bf16_f32 v125, v50, v51
  v_exp_f32 v53, v53
  v_exp_f32 v54, v54
  v_cvt_pk_bf16_f32 v126, v52, v53
  v_exp_f32 v55, v55
  v_exp_f32 v24, v24
  v_cvt_pk_bf16_f32 v127, v54, v55
  v_mfma_f32_32x32x16_bf16 v[40:55], v[128:131], v[20:23], v[72:87]
  v_exp_f32 v25, v25
  v_exp_f32 v26, v26
  v_cvt_pk_bf16_f32 v120, v24, v25
  v_exp_f32 v27, v27
  v_exp_f32 v28, v28
  v_cvt_pk_bf16_f32 v121, v26, v27
  v_mfma_f32_32x32x16_bf16 v[104:119], v[160:163], v[124:127], v[104:119]
  v_exp_f32 v29, v29
  v_exp_f32 v30, v30
  v_cvt_pk_bf16_f32 v122, v28, v29
  v_exp_f32 v31, v31
  v_exp_f32 v32, v32
  v_cvt_pk_bf16_f32 v123, v30, v31
  v_exp_f32 v33, v33
  v_exp_f32 v34, v34
  v_mfma_f32_32x32x16_bf16 v[88:103], v[132:135], v[120:123], v[88:103]
  v_cvt_pk_bf16_f32 v124, v32, v33
  v_exp_f32 v35, v35
  v_exp_f32 v36, v36
  v_cvt_pk_bf16_f32 v125, v34, v35
  v_exp_f32 v37, v37
  v_exp_f32 v38, v38
  v_cvt_pk_bf16_f32 v126, v36, v37
  v_exp_f32 v39, v39
  v_exp_f32 v40, v40
  v_cvt_pk_bf16_f32 v127, v38, v39
  s_waitcnt lgkmcnt(0)
  v_mfma_f32_32x32x16_bf16 v[24:39], v[140:143], v[16:19], v[56:71]
  v_exp_f32 v41, v41
  v_exp_f32 v42, v42
  v_cvt_pk_bf16_f32 v120, v40, v41
  v_exp_f32 v43, v43
  v_exp_f32 v44, v44
  v_cvt_pk_bf16_f32 v121, v42, v43
  v_mfma_f32_32x32x16_bf16 v[88:103], v[136:139], v[124:127], v[88:103]
  ds_read_b128 v[152:155], v8 offset:10240
  s_mov_b64 exec, s[92:93]
  ds_read_b128 v[156:159], v9 offset:10240
  ds_read_b128 v[160:163], v9 offset:10752
  s_mov_b64 exec, -1
  v_exp_f32 v45, v45
  v_exp_f32 v46, v46
  v_cvt_pk_bf16_f32 v122, v44, v45
  v_exp_f32 v47, v47
  v_exp_f32 v48, v48
  v_cvt_pk_bf16_f32 v123, v46, v47
  v_exp_f32 v49, v49
  v_exp_f32 v50, v50
  v_mfma_f32_32x32x16_bf16 v[104:119], v[132:135], v[120:123], v[104:119]
  v_cvt_pk_bf16_f32 v124, v48, v49
  v_exp_f32 v51, v51
  v_exp_f32 v52, v52
  v_cvt_pk_bf16_f32 v125, v50, v51
  v_exp_f32 v53, v53
  v_exp_f32 v54, v54
  v_cvt_pk_bf16_f32 v126, v52, v53
  v_exp_f32 v55, v55
  v_exp_f32 v24, v24
  v_cvt_pk_bf16_f32 v127, v54, v55
  v_mfma_f32_32x32x16_bf16 v[40:55], v[140:143], v[20:23], v[72:87]
  v_exp_f32 v25, v25
  v_exp_f32 v26, v26
  v_cvt_pk_bf16_f32 v120, v24, v25
  v_exp_f32 v27, v27
  v_exp_f32 v28, v28
  v_cvt_pk_bf16_f32 v121, v26, v27
  v_mfma_f32_32x32x16_bf16 v[104:119], v[136:139], v[124:127], v[104:119]
  v_exp_f32 v29, v29
  v_exp_f32 v30, v30
  v_cvt_pk_bf16_f32 v122, v28, v29
  v_exp_f32 v31, v31
  v_exp_f32 v32, v32
  v_cvt_pk_bf16_f32 v123, v30, v31
  v_exp_f32 v33, v33
  v_exp_f32 v34, v34
  v_mfma_f32_32x32x16_bf16 v[88:103], v[144:147], v[120:123], v[88:103]
  v_cvt_pk_bf16_f32 v124, v32, v33
  v_exp_f32 v35, v35
  v_exp_f32 v36, v36
  v_cvt_pk_bf16_f32 v125, v34, v35
  v_exp_f32 v37, v37
  v_exp_f32 v38, v38
  v_cvt_pk_bf16_f32 v126, v36, v37
  v_exp_f32 v39, v39
  v_exp_f32 v40, v40
  v_cvt_pk_bf16_f32 v127, v38, v39
  s_waitcnt lgkmcnt(0)
  v_mfma_f32_32x32x16_bf16 v[24:39], v[152:155], v[16:19], v[56:71]
  v_exp_f32 v41, v41
  v_exp_f32 v42, v42
  v_cvt_pk_bf16_f32 v120, v40, v41
  v_exp_f32 v43, v43
  v_exp_f32 v44, v44
  v_cvt_pk_bf16_f32 v121, v42, v43
  v_mfma_f32_32x32x16_bf16 v[88:103], v[148:151], v[124:127], v[88:103]
  ds_read_b128 v[128:131], v8 offset:12288
  s_mov_b64 exec, s[92:93]
  ds_read_b128 v[132:135], v9 offset:12288
  ds_read_b128 v[136:139], v9 offset:12800
  s_mov_b64 exec, -1
  v_exp_f32 v45, v45
  v_exp_f32 v46, v46
  v_cvt_pk_bf16_f32 v122, v44, v45
  v_exp_f32 v47, v47
  v_exp_f32 v48, v48
  v_cvt_pk_bf16_f32 v123, v46, v47
  v_exp_f32 v49, v49
  v_exp_f32 v50, v50
  v_mfma_f32_32x32x16_bf16 v[104:119], v[144:147], v[120:123], v[104:119]
  v_cvt_pk_bf16_f32 v124, v48, v49
  v_exp_f32 v51, v51
  v_exp_f32 v52, v52
  v_cvt_pk_bf16_f32 v125, v50, v51
  v_exp_f32 v53, v53
  v_exp_f32 v54, v54
  v_cvt_pk_bf16_f32 v126, v52, v53
  v_exp_f32 v55, v55
  v_exp_f32 v24, v24
  v_cvt_pk_bf16_f32 v127, v54, v55
  v_mfma_f32_32x32x16_bf16 v[40:55], v[152:155], v[20:23], v[72:87]
  v_exp_f32 v25, v25
  v_exp_f32 v26, v26
  v_cvt_pk_bf16_f32 v120, v24, v25
  v_exp_f32 v27, v27
  v_exp_f32 v28, v28
  v_cvt_pk_bf16_f32 v121, v26, v27
  v_mfma_f32_32x32x16_bf16 v[104:119], v[148:151], v[124:127], v[104:119]
  v_exp_f32 v29, v29
  v_exp_f32 v30, v30
  v_cvt_pk_bf16_f32 v122, v28, v29
  v_exp_f32 v31, v31
  v_exp_f32 v32, v32
  v_cvt_pk_bf16_f32 v123, v30, v31
  v_exp_f32 v33, v33
  v_exp_f32 v34, v34
  v_mfma_f32_32x32x16_bf16 v[88:103], v[156:159], v[120:123], v[88:103]
  v_cvt_pk_bf16_f32 v124, v32, v33
  v_exp_f32 v35, v35
  v_exp_f32 v36, v36
  v_cvt_pk_bf16_f32 v125, v34, v35
  v_exp_f32 v37, v37
  v_exp_f32 v38, v38
  v_cvt_pk_bf16_f32 v126, v36, v37
  v_exp_f32 v39, v39
  v_exp_f32 v40, v40
  v_cvt_pk_bf16_f32 v127, v38, v39
  s_waitcnt lgkmcnt(0)
  v_mfma_f32_32x32x16_bf16 v[24:39], v[128:131], v[16:19], v[56:71]
  v_exp_f32 v41, v41
  v_exp_f32 v42, v42
  v_cvt_pk_bf16_f32 v120, v40, v41
  v_exp_f32 v43, v43
  v_exp_f32 v44, v44
  v_cvt_pk_bf16_f32 v121, v42, v43
  v_mfma_f32_32x32x16_bf16 v[88:103], v[160:163], v[124:127], v[88:103]
  ds_read_b128 v[140:143], v8 offset:14336
  s_mov_b64 exec, s[92:93]
  ds_read_b128 v[144:147], v9 offset:14336
  ds_read_b128 v[148:151], v9 offset:14848
  s_mov_b64 exec, -1
  v_exp_f32 v45, v45
  v_exp_f32 v46, v46
  v_cvt_pk_bf16_f32 v122, v44, v45
  v_exp_f32 v47, v47
  v_exp_f32 v48, v48
  v_cvt_pk_bf16_f32 v123, v46, v47
  v_exp_f32 v49, v49
  v_exp_f32 v50, v50
  v_mfma_f32_32x32x16_bf16 v[104:119], v[156:159], v[120:123], v[104:119]
  v_cvt_pk_bf16_f32 v124, v48, v49
  v_exp_f32 v51, v51
  v_exp_f32 v52, v52
  v_cvt_pk_bf16_f32 v125, v50, v51
  v_exp_f32 v53, v53
  v_exp_f32 v54, v54
  v_cvt_pk_bf16_f32 v126, v52, v53
  v_exp_f32 v55, v55
  v_exp_f32 v24, v24
  v_cvt_pk_bf16_f32 v127, v54, v55
  v_mfma_f32_32x32x16_bf16 v[40:55], v[128:131], v[20:23], v[72:87]
  v_exp_f32 v25, v25
  v_exp_f32 v26, v26
  v_cvt_pk_bf16_f32 v120, v24, v25
  v_exp_f32 v27, v27
  v_exp_f32 v28, v28
  v_cvt_pk_bf16_f32 v121, v26, v27
  v_mfma_f32_32x32x16_bf16 v[104:119], v[160:163], v[124:127], v[104:119]
  v_exp_f32 v29, v29
  v_exp_f32 v30, v30
  v_cvt_pk_bf16_f32 v122, v28, v29
  v_exp_f32 v31, v31
  v_exp_f32 v32, v32
  v_cvt_pk_bf16_f32 v123, v30, v31
  v_exp_f32 v33, v33
  v_exp_f32 v34, v34
  v_mfma_f32_32x32x16_bf16 v[88:103], v[132:135], v[120:123], v[88:103]
  v_cvt_pk_bf16_f32 v124, v32, v33
  v_exp_f32 v35, v35
  v_exp_f32 v36, v36
  v_cvt_pk_bf16_f32 v125, v34, v35
  v_exp_f32 v37, v37
  v_exp_f32 v38, v38
  v_cvt_pk_bf16_f32 v126, v36, v37
  v_exp_f32 v39, v39
  v_exp_f32 v40, v40
  v_cvt_pk_bf16_f32 v127, v38, v39
  s_waitcnt lgkmcnt(0)
  v_mfma_f32_32x32x16_bf16 v[24:39], v[140:143], v[16:19], v[56:71]
  v_exp_f32 v41, v41
  v_exp_f32 v42, v42
  v_cvt_pk_bf16_f32 v120, v40, v41
  v_exp_f32 v43, v43
  v_exp_f32 v44, v44
  v_cvt_pk_bf16_f32 v121, v42, v43
  v_mfma_f32_32x32x16_bf16 v[88:103], v[136:139], v[124:127], v[88:103]
  ds_read_b128 v[152:155], v8 offset:16384
  s_mov_b64 exec, s[92:93]
  ds_read_b128 v[156:159], v9 offset:16384
  ds_read_b128 v[160:163], v9 offset:16896
  s_mov_b64 exec, -1
  v_add_u32 v8, s84, v8
  v_add_u32 v9, s84, v9
  s_bitcmp1_b32 s91, s85
  v_exp_f32 v45, v45
  v_exp_f32 v46, v46
  v_cvt_pk_bf16_f32 v122, v44, v45
  v_exp_f32 v47, v47
  v_exp_f32 v48, v48
  v_cvt_pk_bf16_f32 v123, v46, v47
  v_exp_f32 v49, v49
  v_exp_f32 v50, v50
  v_mfma_f32_32x32x16_bf16 v[104:119], v[132:135], v[120:123], v[104:119]
  v_cvt_pk_bf16_f32 v124, v48, v49
  v_exp_f32 v51, v51
  v_exp_f32 v52, v52
  v_cvt_pk_bf16_f32 v125, v50, v51
  v_exp_f32 v53, v53
  v_exp_f32 v54, v54
  v_cvt_pk_bf16_f32 v126, v52, v53
  v_exp_f32 v55, v55
  s_cbranch_scc1 L_dloop
  s_cmp_eq_u32 s85, 6
  s_cbranch_scc1 L_dexit
  v_cvt_pk_bf16_f32 v127, v54, v55
  v_frexp_exp_i32_f32 v14, v96
  v_add_u32 v14, 94, v14
  v_mfma_f32_32x32x16_bf16 v[104:119], v[136:139], v[124:127], v[104:119]
  v_max_i32 v14, 0, v14
  v_sub_u32 v13, 0, v14
  v_cvt_f32_i32 v14, v13
  v_add_u32 v6, v6, v13
  v_ldexp_f32 v88, v88, v13
  v_ldexp_f32 v89, v89, v13
  v_ldexp_f32 v90, v90, v13
  v_ldexp_f32 v91, v91, v13
  v_ldexp_f32 v92, v92, v13
  v_ldexp_f32 v93, v93, v13
  v_ldexp_f32 v94, v94, v13
  v_ldexp_f32 v95, v95, v13
  v_ldexp_f32 v96, v96, v13
  v_add_f32 v56, v56, v14
  v_add_f32 v57, v57, v14
  v_pk_add_f32 v[24:25], v[24:25], v[14:15] op_sel_hi:[1,0]
  v_pk_add_f32 v[26:27], v[26:27], v[14:15] op_sel_hi:[1,0]
  v_pk_add_f32 v[28:29], v[28:29], v[14:15] op_sel_hi:[1,0]
  v_pk_add_f32 v[30:31], v[30:31], v[14:15] op_sel_hi:[1,0]
  v_pk_add_f32 v[32:33], v[32:33], v[14:15] op_sel_hi:[1,0]
  v_pk_add_f32 v[34:35], v[34:35], v[14:15] op_sel_hi:[1,0]
  v_pk_add_f32 v[36:37], v[36:37], v[14:15] op_sel_hi:[1,0]
  v_pk_add_f32 v[38:39], v[38:39], v[14:15] op_sel_hi:[1,0]
  v_frexp_exp_i32_f32 v14, v112
  v_add_u32 v14, 94, v14
  v_max_i32 v14, 0, v14
  v_sub_u32 v13, 0, v14
  v_cvt_f32_i32 v14, v13
  v_add_u32 v7, v7, v13
  v_add_f32 v72, v72, v14
  v_add_f32 v73, v73, v14
  v_mov_b64 v[74:75], v[72:73]
  v_mov_b64 v[76:77], v[72:73]
  v_mov_b64 v[78:79], v[72:73]
  v_mov_b64 v[80:81], v[72:73]
  v_mov_b64 v[82:83], v[72:73]
  v_mov_b64 v[84:85], v[72:73]
  v_mov_b64 v[86:87], v[72:73]
  v_mov_b64 v[58:59], v[56:57]
  v_mov_b64 v[60:61], v[56:57]
  v_mov_b64 v[62:63], v[56:57]
  v_mov_b64 v[64:65], v[56:57]
  v_mov_b64 v[66:67], v[56:57]
  v_mov_b64 v[68:69], v[56:57]
  v_mov_b64 v[70:71], v[56:57]
  v_ldexp_f32 v104, v104, v13
  v_ldexp_f32 v105, v105, v13
  v_ldexp_f32 v106, v106, v13
  v_ldexp_f32 v107, v107, v13
  v_ldexp_f32 v108, v108, v13
  v_ldexp_f32 v109, v109, v13
  v_ldexp_f32 v110, v110, v13
  v_ldexp_f32 v111, v111, v13
  v_ldexp_f32 v112, v112, v13
  v_mov_b64 v[124:125], 0
  v_mov_b64 v[126:127], 0
  v_mov_b64 v[54:55], 0
  s_branch L_dloop
L_dexit:
  ds_read_b128 v[72:75], v2
  v_cvt_pk_bf16_f32 v127, v54, v55
  ds_read_b128 v[76:79], v2 offset:1024
  ds_read_b32 v80, v10
  v_mfma_f32_32x32x16_bf16 v[104:119], v[136:139], v[124:127], v[104:119]
  ds_read_b128 v[56:59], v2 offset:2048
  ds_read_b128 v[60:63], v2 offset:3072
  ds_read_b32 v64, v10 offset:128
  v_mov_b32 v13, 115712
  ds_read_b64 v[14:15], v13
  s_lshl_b32 s7, s4, 12
  s_add_u32 s84, s82, s7
  s_lshl_b32 s7, s78, 11
  s_add_u32 s84, s84, s7
  s_add_u32 s84, s84, 3145728
  v_mov_b32 v13, 0x0c000000
  s_waitcnt lgkmcnt(4)
  v_ldexp_f32 v72, v72, v6
  v_ldexp_f32 v73, v73, v6
  v_ldexp_f32 v74, v74, v6
  v_ldexp_f32 v75, v75, v6
  v_ldexp_f32 v76, v76, v6
  v_ldexp_f32 v77, v77, v6
  v_ldexp_f32 v78, v78, v6
  v_ldexp_f32 v79, v79, v6
  v_ldexp_f32 v80, v80, v6
  s_waitcnt lgkmcnt(0)
  v_ldexp_f32 v56, v56, v7
  v_ldexp_f32 v57, v57, v7
  v_ldexp_f32 v58, v58, v7
  v_ldexp_f32 v59, v59, v7
  v_ldexp_f32 v60, v60, v7
  v_ldexp_f32 v61, v61, v7
  v_ldexp_f32 v62, v62, v7
  v_ldexp_f32 v63, v63, v7
  v_ldexp_f32 v64, v64, v7
  v_readfirstlane_b32 s85, v14
  v_readfirstlane_b32 s76, v15
  v_mov_b32 v15, 0x7e000000
  v_add_f32 v96, v96, v80
  v_pk_add_f32 v[88:89], v[88:89], v[72:73]
  v_pk_add_f32 v[90:91], v[90:91], v[74:75]
  v_pk_add_f32 v[92:93], v[92:93], v[76:77]
  v_pk_add_f32 v[94:95], v[94:95], v[78:79]
  v_add_f32 v112, v112, v64
  v_pk_add_f32 v[104:105], v[104:105], v[56:57]
  v_pk_add_f32 v[106:107], v[106:107], v[58:59]
  v_pk_add_f32 v[108:109], v[108:109], v[60:61]
  v_pk_add_f32 v[110:111], v[110:111], v[62:63]
  v_rcp_f32 v72, v96
  v_rcp_f32 v80, v112
  v_add_f32 v73, |v88|, |v89|
  v_add_f32 v81, |v104|, |v105|
  v_add_f32 v74, |v90|, |v91|
  v_add_f32 v82, |v106|, |v107|
  v_add_f32 v75, |v92|, |v93|
  v_add_f32 v83, |v108|, |v109|
  v_add_f32 v76, |v94|, |v95|
  v_add_f32 v84, |v110|, |v111|
  v_add_f32 v73, v73, v74
  v_add_f32 v81, v81, v82
  v_add_f32 v75, v75, v76
  v_add_f32 v83, v83, v84
  v_add_f32 v75, v73, v75
  v_add_f32 v83, v81, v83
  v_add_f32 v73, v75, v96
  v_add_f32 v81, v83, v112
  v_cmp_gt_f32 s[8:9], v13, v75
  v_cmp_gt_f32 s[42:43], v13, v83
  v_cmp_nlt_f32 s[40:41], v73, v15
  v_cmp_nlt_f32 s[44:45], v81, v15
  v_pk_mul_f32 v[88:89], v[88:89], v[72:73] op_sel_hi:[1,0]
  v_pk_mul_f32 v[104:105], v[104:105], v[80:81] op_sel_hi:[1,0]
  v_pk_mul_f32 v[90:91], v[90:91], v[72:73] op_sel_hi:[1,0]
  v_pk_mul_f32 v[106:107], v[106:107], v[80:81] op_sel_hi:[1,0]
  v_pk_mul_f32 v[92:93], v[92:93], v[72:73] op_sel_hi:[1,0]
  v_pk_mul_f32 v[108:109], v[108:109], v[80:81] op_sel_hi:[1,0]
  v_pk_mul_f32 v[94:95], v[94:95], v[72:73] op_sel_hi:[1,0]
  v_pk_mul_f32 v[110:111], v[110:111], v[80:81] op_sel_hi:[1,0]
  s_or_b64 s[8:9], s[8:9], s[40:41]
  s_cbranch_scc1 L_fba
L_fbra:
  s_or_b64 s[42:43], s[42:43], s[44:45]
  s_cbranch_scc1 L_fbb
L_fbrb:
  v_cvt_pk_bf16_f32 v140, v88, v89
  v_cvt_pk_bf16_f32 v141, v90, v91
  v_cvt_pk_bf16_f32 v142, v92, v93
  v_cvt_pk_bf16_f32 v143, v94, v95
  v_cvt_pk_bf16_f32 v144, v104, v105
  v_cvt_pk_bf16_f32 v145, v106, v107
  v_cvt_pk_bf16_f32 v146, v108, v109
  v_cvt_pk_bf16_f32 v147, v110, v111
  buffer_store_dwordx4 v[140:143], v1, s[60:63], s84 offen sc1
  buffer_store_dwordx4 v[144:147], v1, s[60:63], s84 offen offset:1024 sc1
L_st_r:
  v_add_u32 v13, 65536, v12
  v_add_u32 v14, 131072, v12
  ds_read_b64_tr_b16 v[24:25], v13 offset:0
  ds_read_b64_tr_b16 v[26:27], v13 offset:1024
  ds_read_b64_tr_b16 v[28:29], v13 offset:2048
  ds_read_b64_tr_b16 v[30:31], v13 offset:3072
  ds_read_b64_tr_b16 v[32:33], v13 offset:4096
  ds_read_b64_tr_b16 v[34:35], v13 offset:5120
  ds_read_b64_tr_b16 v[36:37], v13 offset:6144
  ds_read_b64_tr_b16 v[38:39], v13 offset:7168
  ds_read_b64_tr_b16 v[40:41], v13 offset:8192
  ds_read_b64_tr_b16 v[42:43], v13 offset:9216
  ds_read_b64_tr_b16 v[44:45], v13 offset:10240
  ds_read_b64_tr_b16 v[46:47], v13 offset:11264
  ds_read_b64_tr_b16 v[48:49], v13 offset:12288
  ds_read_b64_tr_b16 v[50:51], v13 offset:13312
  ds_read_b64_tr_b16 v[52:53], v13 offset:14336
  ds_read_b64_tr_b16 v[54:55], v13 offset:15360
  ds_read_b64_tr_b16 v[56:57], v13 offset:16384
  ds_read_b64_tr_b16 v[58:59], v13 offset:17408
  ds_read_b64_tr_b16 v[60:61], v13 offset:18432
  ds_read_b64_tr_b16 v[62:63], v13 offset:19456
  ds_read_b64_tr_b16 v[64:65], v13 offset:20480
  ds_read_b64_tr_b16 v[66:67], v13 offset:21504
  ds_read_b64_tr_b16 v[68:69], v13 offset:22528
  ds_read_b64_tr_b16 v[70:71], v13 offset:23552
  ds_read_b64_tr_b16 v[72:73], v13 offset:24576
  ds_read_b64_tr_b16 v[74:75], v13 offset:25600
  ds_read_b64_tr_b16 v[76:77], v13 offset:26624
  ds_read_b64_tr_b16 v[78:79], v13 offset:27648
  ds_read_b64_tr_b16 v[80:81], v13 offset:28672
  ds_read_b64_tr_b16 v[82:83], v13 offset:29696
  ds_read_b64_tr_b16 v[84:85], v13 offset:30720
  ds_read_b64_tr_b16 v[86:87], v13 offset:31744
  s_lshl_b32 s6, s77, 7
  s_add_u32 s6, s6, 589824
  v_mov_b32 v16, s76
  s_lshl_b32 s84, s5, 10
  s_lshl_b32 s8, s3, 7
  s_add_u32 s84, s84, s8
  s_add_u32 s84, s84, 589824
  v_lshlrev_b32 v17, 9, v0
  s_lshl_b32 s9, s5, 16
  s_add_u32 s9, s9, s38
  s_add_u32 s9, s9, 3145728
  s_lshl_b32 s7, s79, 14
  s_add_u32 s7, s7, 65536
  v_add_u32 v8, s7, v1
  v_and_b32 v9, 31, v0
  v_lshlrev_b32 v9, 11, v9
  v_lshrrev_b32 v10, 5, v0
  v_lshl_add_u32 v9, v10, 4, v9
  s_waitcnt vmcnt(0) lgkmcnt(0)
  s_barrier
  s_cmp_lg_u32 s3, 3
  s_cbranch_scc1 L_nofl3
  s_mov_b64 exec, 1
  s_cmp_eq_u32 s85, 1
  s_cbranch_scc1 L_ff1
  buffer_store_dword v16, v164, s[60:63], s6 offen sc1
  s_branch L_nofl3
L_ff1:
  buffer_store_dword v16, v164, s[60:63], s6 offen
L_nofl3:
  s_mov_b64 exec, 3
  s_mov_b32 s7, 0
L_pb1:
  buffer_load_dword v18, v17, s[60:63], s84 offen sc1
  s_waitcnt vmcnt(0)
  v_cmp_ne_u32 vcc, s76, v18
  s_add_u32 s7, s7, 1
  s_cmp_ge_u32 s7, 1048576
  s_cbranch_scc1 L_pb1_x
  s_nop 1
  s_cbranch_vccnz L_pb1
L_pb1_x:
  s_mov_b64 exec, -1
  s_add_u32 m0, s38, 65536
  s_add_u32 s8, s9, 0
  buffer_load_dwordx4 v1, s[60:63], s8 offen offset:0 sc1 lds
  buffer_load_dwordx4 v1, s[60:63], s8 offen offset:1024 sc1 lds
  buffer_load_dwordx4 v1, s[60:63], s8 offen offset:2048 sc1 lds
  buffer_load_dwordx4 v1, s[60:63], s8 offen offset:3072 sc1 lds
  s_add_u32 m0, s38, 81920
  s_add_u32 s8, s9, 32768
  buffer_load_dwordx4 v1, s[60:63], s8 offen offset:0 sc1 lds
  buffer_load_dwordx4 v1, s[60:63], s8 offen offset:1024 sc1 lds
  buffer_load_dwordx4 v1, s[60:63], s8 offen offset:2048 sc1 lds
  buffer_load_dwordx4 v1, s[60:63], s8 offen offset:3072 sc1 lds
  s_add_u32 m0, s38, 98304
  s_add_u32 s8, s9, 16384
  buffer_load_dwordx4 v1, s[60:63], s8 offen offset:0 sc1 lds
  buffer_load_dwordx4 v1, s[60:63], s8 offen offset:1024 sc1 lds
  buffer_load_dwordx4 v1, s[60:63], s8 offen offset:2048 sc1 lds
  buffer_load_dwordx4 v1, s[60:63], s8 offen offset:3072 sc1 lds
  s_add_u32 m0, s38, 114688
  s_add_u32 s8, s9, 49152
  buffer_load_dwordx4 v1, s[60:63], s8 offen offset:0 sc1 lds
  buffer_load_dwordx4 v1, s[60:63], s8 offen offset:1024 sc1 lds
  buffer_load_dwordx4 v1, s[60:63], s8 offen offset:2048 sc1 lds
  buffer_load_dwordx4 v1, s[60:63], s8 offen offset:3072 sc1 lds
  s_waitcnt vmcnt(8)
  s_barrier
  ds_read_b128 v[88:91], v8 offset:0
  ds_read_b128 v[92:95], v8 offset:1024
  ds_read_b128 v[96:99], v8 offset:2048
  ds_read_b128 v[100:103], v8 offset:3072
  ds_read_b128 v[104:107], v8 offset:4096
  ds_read_b128 v[108:111], v8 offset:5120
  ds_read_b128 v[112:115], v8 offset:6144
  ds_read_b128 v[116:119], v8 offset:7168
  ds_read_b128 v[120:123], v8 offset:8192
  ds_read_b128 v[124:127], v8 offset:9216
  ds_read_b128 v[128:131], v8 offset:10240
  ds_read_b128 v[132:135], v8 offset:11264
  ds_read_b128 v[136:139], v8 offset:12288
  ds_read_b128 v[140:143], v8 offset:13312
  s_waitcnt lgkmcnt(13)
  v_mfma_f32_32x32x16_bf16 v[148:163], v[24:27], v[88:91], 0
  ds_read_b128 v[144:147], v8 offset:14336
  s_waitcnt lgkmcnt(13)
  v_mfma_f32_32x32x16_bf16 v[148:163], v[28:31], v[92:95], v[148:163]
  ds_read_b64_tr_b16 v[24:25], v14 offset:0
  ds_read_b64_tr_b16 v[26:27], v14 offset:1024
  ds_read_b128 v[88:91], v8 offset:15360
  s_waitcnt lgkmcnt(15)
  v_mfma_f32_32x32x16_bf16 v[148:163], v[32:35], v[96:99], v[148:163]
  ds_read_b64_tr_b16 v[28:29], v14 offset:2048
  ds_read_b64_tr_b16 v[30:31], v14 offset:3072
  s_waitcnt lgkmcnt(15)
  v_mfma_f32_32x32x16_bf16 v[148:163], v[36:39], v[100:103], v[148:163]
  ds_read_b64_tr_b16 v[32:33], v14 offset:4096
  ds_read_b64_tr_b16 v[34:35], v14 offset:5120
  v_mfma_f32_32x32x16_bf16 v[148:163], v[40:43], v[104:107], v[148:163]
  ds_read_b64_tr_b16 v[36:37], v14 offset:6144
  ds_read_b64_tr_b16 v[38:39], v14 offset:7168
  s_waitcnt lgkmcnt(15)
  v_mfma_f32_32x32x16_bf16 v[148:163], v[44:47], v[108:111], v[148:163]
  ds_read_b64_tr_b16 v[40:41], v14 offset:8192
  ds_read_b64_tr_b16 v[42:43], v14 offset:9216
  v_mfma_f32_32x32x16_bf16 v[148:163], v[48:51], v[112:115], v[148:163]
  ds_read_b64_tr_b16 v[44:45], v14 offset:10240
  ds_read_b64_tr_b16 v[46:47], v14 offset:11264
  v_mfma_f32_32x32x16_bf16 v[148:163], v[52:55], v[116:119], v[148:163]
  ds_read_b64_tr_b16 v[48:49], v14 offset:12288
  ds_read_b64_tr_b16 v[50:51], v14 offset:13312
  v_mfma_f32_32x32x16_bf16 v[148:163], v[56:59], v[120:123], v[148:163]
  ds_read_b64_tr_b16 v[52:53], v14 offset:14336
  ds_read_b64_tr_b16 v[54:55], v14 offset:15360
  s_waitcnt lgkmcnt(15)
  v_mfma_f32_32x32x16_bf16 v[148:163], v[60:63], v[124:127], v[148:163]
  ds_read_b64_tr_b16 v[56:57], v14 offset:16384
  ds_read_b64_tr_b16 v[58:59], v14 offset:17408
  s_waitcnt vmcnt(0)
  s_barrier
  v_mfma_f32_32x32x16_bf16 v[148:163], v[64:67], v[128:131], v[148:163]
  ds_read_b64_tr_b16 v[60:61], v14 offset:18432
  ds_read_b64_tr_b16 v[62:63], v14 offset:19456
  ds_read_b128 v[92:95], v8 offset:32768
  ds_read_b128 v[96:99], v8 offset:33792
  v_mfma_f32_32x32x16_bf16 v[148:163], v[68:71], v[132:135], v[148:163]
  ds_read_b64_tr_b16 v[64:65], v14 offset:20480
  ds_read_b64_tr_b16 v[66:67], v14 offset:21504
  ds_read_b128 v[100:103], v8 offset:34816
  ds_read_b128 v[104:107], v8 offset:35840
  v_mfma_f32_32x32x16_bf16 v[148:163], v[72:75], v[136:139], v[148:163]
  ds_read_b64_tr_b16 v[68:69], v14 offset:22528
  ds_read_b64_tr_b16 v[70:71], v14 offset:23552
  ds_read_b128 v[108:111], v8 offset:36864
  ds_read_b128 v[112:115], v8 offset:37888
  v_mfma_f32_32x32x16_bf16 v[148:163], v[76:79], v[140:143], v[148:163]
  ds_read_b64_tr_b16 v[72:73], v14 offset:24576
  ds_read_b64_tr_b16 v[74:75], v14 offset:25600
  ds_read_b128 v[116:119], v8 offset:38912
  ds_read_b128 v[120:123], v8 offset:39936
  v_mfma_f32_32x32x16_bf16 v[148:163], v[80:83], v[144:147], v[148:163]
  ds_read_b64_tr_b16 v[76:77], v14 offset:26624
  ds_read_b64_tr_b16 v[78:79], v14 offset:27648
  ds_read_b128 v[124:127], v8 offset:40960
  ds_read_b128 v[128:131], v8 offset:41984
  s_waitcnt lgkmcnt(15)
  v_mfma_f32_32x32x16_bf16 v[148:163], v[84:87], v[88:91], v[148:163]
  ds_read_b64_tr_b16 v[80:81], v14 offset:28672
  ds_read_b64_tr_b16 v[82:83], v14 offset:29696
  ds_read_b128 v[132:135], v8 offset:43008
  ds_read_b128 v[136:139], v8 offset:44032
  v_mfma_f32_32x32x16_bf16 v[148:163], v[24:27], v[92:95], v[148:163]
  ds_read_b64_tr_b16 v[84:85], v14 offset:30720
  ds_read_b64_tr_b16 v[86:87], v14 offset:31744
  ds_read_b128 v[140:143], v8 offset:45056
  ds_read_b128 v[144:147], v8 offset:46080
  v_mfma_f32_32x32x16_bf16 v[148:163], v[28:31], v[96:99], v[148:163]
  ds_read_b128 v[88:91], v8 offset:47104
  ds_read_b128 v[92:95], v8 offset:48128
  s_waitcnt lgkmcnt(15)
  v_mfma_f32_32x32x16_bf16 v[148:163], v[32:35], v[100:103], v[148:163]
  v_mfma_f32_32x32x16_bf16 v[148:163], v[36:39], v[104:107], v[148:163]
  v_mfma_f32_32x32x16_bf16 v[148:163], v[40:43], v[108:111], v[148:163]
  v_mfma_f32_32x32x16_bf16 v[148:163], v[44:47], v[112:115], v[148:163]
  v_mfma_f32_32x32x16_bf16 v[148:163], v[48:51], v[116:119], v[148:163]
  s_waitcnt lgkmcnt(14)
  v_mfma_f32_32x32x16_bf16 v[148:163], v[52:55], v[120:123], v[148:163]
  s_waitcnt lgkmcnt(11)
  v_mfma_f32_32x32x16_bf16 v[148:163], v[56:59], v[124:127], v[148:163]
  s_waitcnt lgkmcnt(10)
  v_mfma_f32_32x32x16_bf16 v[148:163], v[60:63], v[128:131], v[148:163]
  s_waitcnt lgkmcnt(7)
  v_mfma_f32_32x32x16_bf16 v[148:163], v[64:67], v[132:135], v[148:163]
  s_waitcnt lgkmcnt(6)
  v_mfma_f32_32x32x16_bf16 v[148:163], v[68:71], v[136:139], v[148:163]
  s_waitcnt lgkmcnt(3)
  v_mfma_f32_32x32x16_bf16 v[148:163], v[72:75], v[140:143], v[148:163]
  s_waitcnt lgkmcnt(2)
  v_mfma_f32_32x32x16_bf16 v[148:163], v[76:79], v[144:147], v[148:163]
  s_waitcnt lgkmcnt(1)
  v_mfma_f32_32x32x16_bf16 v[148:163], v[80:83], v[88:91], v[148:163]
  s_waitcnt lgkmcnt(0)
  v_mfma_f32_32x32x16_bf16 v[148:163], v[84:87], v[92:95], v[148:163]
  s_nop 11
  v_cvt_pk_bf16_f32 v24, v148, v149
  v_cvt_pk_bf16_f32 v25, v150, v151
  v_cvt_pk_bf16_f32 v26, v152, v153
  v_cvt_pk_bf16_f32 v27, v154, v155
  v_cvt_pk_bf16_f32 v28, v156, v157
  v_cvt_pk_bf16_f32 v29, v158, v159
  v_cvt_pk_bf16_f32 v30, v160, v161
  v_cvt_pk_bf16_f32 v31, v162, v163
  v_permlane32_swap_b32 v24, v26
  v_permlane32_swap_b32 v25, v27
  v_permlane32_swap_b32 v28, v30
  v_permlane32_swap_b32 v29, v31
  buffer_store_dwordx4 v[24:27], v9, s[68:71], s83 offen offset:1024
  buffer_store_dwordx4 v[28:31], v9, s[68:71], s83 offen offset:1056
  s_branch L_fin
L_F:
  v_add_u32 v8, 116736, v1
  v_lshlrev_b32 v11, 4, v5
  v_lshrrev_b32 v13, 5, v0
  v_lshl_add_u32 v11, v13, 8, v11
  v_add_u32 v9, 117760, v11
  v_mov_b64 v[88:89], 0
  v_mov_b64 v[90:91], 0
  v_mov_b64 v[92:93], 0
  v_mov_b64 v[94:95], 0
  v_mov_b64 v[96:97], 0
  v_mov_b64 v[98:99], 0
  v_mov_b64 v[100:101], 0
  v_mov_b64 v[102:103], 0
  v_mov_b64 v[104:105], 0
  v_mov_b64 v[106:107], 0
  v_mov_b64 v[108:109], 0
  v_mov_b64 v[110:111], 0
  v_mov_b64 v[112:113], 0
  v_mov_b64 v[114:115], 0
  v_mov_b64 v[116:117], 0
  v_mov_b64 v[118:119], 0
  v_mov_b64 v[124:125], 0
  v_mov_b64 v[126:127], 0
  v_mov_b64 v[132:133], 0
  v_mov_b64 v[134:135], 0
  v_mov_b64 v[136:137], 0
  v_mov_b64 v[138:139], 0
  v_mov_b64 v[144:145], 0
  v_mov_b64 v[146:147], 0
  v_mov_b64 v[148:149], 0
  v_mov_b64 v[150:151], 0
  v_mov_b64 v[156:157], 0
  v_mov_b64 v[158:159], 0
  v_mov_b64 v[160:161], 0
  v_mov_b64 v[162:163], 0
  s_mov_b32 exec_lo, 0x110000
  s_mov_b32 exec_hi, 0x110000
  v_mov_b32 v14, 0x3f803f80
  v_mov_b32 v15, v14
  v_mov_b64 v[132:133], v[14:15]
  v_mov_b64 v[134:135], v[14:15]
  v_mov_b64 v[136:137], v[14:15]
  v_mov_b64 v[138:139], v[14:15]
  v_mov_b64 v[144:145], v[14:15]
  v_mov_b64 v[146:147], v[14:15]
  v_mov_b64 v[148:149], v[14:15]
  v_mov_b64 v[150:151], v[14:15]
  v_mov_b64 v[156:157], v[14:15]
  v_mov_b64 v[158:159], v[14:15]
  v_mov_b64 v[160:161], v[14:15]
  v_mov_b64 v[162:163], v[14:15]
  s_mov_b64 exec, -1
  s_mov_b32 s92, 0xffff
  s_mov_b32 s93, 0xffff
  s_lshl_b32 s6, s86, 11
  s_add_u32 s6, s6, 0
  v_add_u32 v13, s6, v1
  v_add_u32 v12, 133120, v1
  s_lshl_b32 s6, s86, 12
  s_add_u32 s6, s6, 98304
  v_add_u32 v6, s6, v1
  v_and_b32 v10, 31, v0
  s_lshl_b32 s6, s86, 8
  s_add_u32 s6, s6, 114688
  v_lshl_add_u32 v10, v10, 2, s6
  s_waitcnt lgkmcnt(0)
  s_bitcmp1_b32 s4, 0
  s_cbranch_scc1 L_f1
  s_barrier
  s_cmp_lg_u32 s80, 0
  s_cbranch_scc1 L_f1
  s_barrier
L_f1:
  s_barrier
  s_barrier
  s_barrier
  s_barrier
  s_setprio 0
  s_barrier
  ds_read_b128 v[16:19], v13
  ds_read_b128 v[20:23], v13 offset:1024
  ds_read_b128 v[152:155], v12
  s_waitcnt lgkmcnt(0)
  s_barrier
  v_mfma_f32_32x32x16_bf16 v[24:39], v[152:155], v[16:19], 0
  v_mfma_f32_32x32x16_bf16 v[40:55], v[152:155], v[20:23], 0
  ds_read_b128 v[128:131], v8 offset:40960
  s_mov_b64 exec, s[92:93]
  ds_read_b128 v[132:135], v9 offset:40960
  ds_read_b128 v[136:139], v9 offset:41472
  s_mov_b64 exec, -1
  s_nop 5
  v_max3_f32 v56, v24, v25, v26
  v_max3_f32 v56, v56, v27, v28
  v_max3_f32 v56, v56, v29, v30
  v_max3_f32 v56, v56, v31, v32
  v_max3_f32 v56, v56, v33, v34
  v_max3_f32 v56, v56, v35, v36
  v_max3_f32 v56, v56, v37, v38
  v_max_f32 v56, v56, v39
  v_mov_b32 v57, v56
  v_max3_f32 v72, v40, v41, v42
  v_max3_f32 v72, v72, v43, v44
  v_max3_f32 v72, v72, v45, v46
  v_max3_f32 v72, v72, v47, v48
  v_max3_f32 v72, v72, v49, v50
  v_max3_f32 v72, v72, v51, v52
  v_max3_f32 v72, v72, v53, v54
  v_max_f32 v72, v72, v55
  v_mov_b32 v73, v72
  v_permlane32_swap_b32 v56, v57
  s_nop 0
  v_permlane32_swap_b32 v72, v73
  v_max_f32 v56, v56, v57
  v_sub_f32 v56, 0xc2be0000, v56
  v_mov_b32 v57, v56
  v_max_f32 v72, v72, v73
  v_sub_f32 v72, 0xc2be0000, v72
  v_mov_b32 v73, v72
  v_mov_b64 v[58:59], v[56:57]
  v_mov_b64 v[60:61], v[56:57]
  v_mov_b64 v[62:63], v[56:57]
  v_mov_b64 v[64:65], v[56:57]
  v_mov_b64 v[66:67], v[56:57]
  v_mov_b64 v[68:69], v[56:57]
  v_mov_b64 v[70:71], v[56:57]
  v_mov_b64 v[74:75], v[72:73]
  v_mov_b64 v[76:77], v[72:73]
  v_mov_b64 v[78:79], v[72:73]
  v_mov_b64 v[80:81], v[72:73]
  v_mov_b64 v[82:83], v[72:73]
  v_mov_b64 v[84:85], v[72:73]
  v_mov_b64 v[86:87], v[72:73]
  v_mov_b64 v[54:55], 0
  s_waitcnt lgkmcnt(0)
  v_mfma_f32_32x32x16_bf16 v[24:39], v[128:131], v[16:19], v[56:71]
  s_nop 11
  v_exp_f32 v24, v24
  v_cvt_pk_bf16_f32 v127, v54, v55
  v_mfma_f32_32x32x16_bf16 v[40:55], v[128:131], v[20:23], v[72:87]
  v_exp_f32 v25, v25
  v_exp_f32 v26, v26
  v_cvt_pk_bf16_f32 v120, v24, v25
  v_exp_f32 v27, v27
  v_exp_f32 v28, v28
  v_cvt_pk_bf16_f32 v121, v26, v27
  v_mfma_f32_32x32x16_bf16 v[104:119], v[160:163], v[124:127], v[104:119]
  ds_read_b128 v[140:143], v8 offset:43008
  s_mov_b64 exec, s[92:93]
  ds_read_b128 v[144:147], v9 offset:43008
  ds_read_b128 v[148:151], v9 offset:43520
  s_mov_b64 exec, -1
  v_exp_f32 v29, v29
  v_exp_f32 v30, v30
  v_cvt_pk_bf16_f32 v122, v28, v29
  v_exp_f32 v31, v31
  v_exp_f32 v32, v32
  v_cvt_pk_bf16_f32 v123, v30, v31
  v_exp_f32 v33, v33
  v_exp_f32 v34, v34
  v_mfma_f32_32x32x16_bf16 v[88:103], v[132:135], v[120:123], v[88:103]
  v_cvt_pk_bf16_f32 v124, v32, v33
  v_exp_f32 v35, v35
  v_exp_f32 v36, v36
  v_cvt_pk_bf16_f32 v125, v34, v35
  v_exp_f32 v37, v37
  v_exp_f32 v38, v38
  v_cvt_pk_bf16_f32 v126, v36, v37
  v_exp_f32 v39, v39
  v_exp_f32 v40, v40
  v_cvt_pk_bf16_f32 v127, v38, v39
  s_waitcnt lgkmcnt(0)
  v_mfma_f32_32x32x16_bf16 v[24:39], v[140:143], v[16:19], v[56:71]
  v_exp_f32 v41, v41
  v_exp_f32 v42, v42
  v_cvt_pk_bf16_f32 v120, v40, v41
  v_exp_f32 v43, v43
  v_exp_f32 v44, v44
  v_cvt_pk_bf16_f32 v121, v42, v43
  v_mfma_f32_32x32x16_bf16 v[88:103], v[136:139], v[124:127], v[88:103]
  v_exp_f32 v45, v45
  v_exp_f32 v46, v46
  v_cvt_pk_bf16_f32 v122, v44, v45
  v_exp_f32 v47, v47
  v_exp_f32 v48, v48
  v_cvt_pk_bf16_f32 v123, v46, v47
  v_exp_f32 v49, v49
  v_exp_f32 v50, v50
  v_mfma_f32_32x32x16_bf16 v[104:119], v[132:135], v[120:123], v[104:119]
  v_cvt_pk_bf16_f32 v124, v48, v49
  v_exp_f32 v51, v51
  v_exp_f32 v52, v52
  v_cvt_pk_bf16_f32 v125, v50, v51
  v_exp_f32 v53, v53
  v_exp_f32 v54, v54
  v_cvt_pk_bf16_f32 v126, v52, v53
  v_exp_f32 v55, v55
  s_waitcnt lgkmcnt(0)
  s_barrier
  v_exp_f32 v24, v24
  v_cvt_pk_bf16_f32 v127, v54, v55
  v_mfma_f32_32x32x16_bf16 v[40:55], v[140:143], v[20:23], v[72:87]
  v_exp_f32 v25, v25
  v_exp_f32 v26, v26
  v_cvt_pk_bf16_f32 v120, v24, v25
  v_exp_f32 v27, v27
  v_exp_f32 v28, v28
  v_cvt_pk_bf16_f32 v121, v26, v27
  v_mfma_f32_32x32x16_bf16 v[104:119], v[136:139], v[124:127], v[104:119]
  ds_read_b128 v[152:155], v8 offset:18432
  s_mov_b64 exec, s[92:93]
  ds_read_b128 v[156:159], v9 offset:18432
  ds_read_b128 v[160:163], v9 offset:18944
  s_mov_b64 exec, -1
  v_exp_f32 v29, v29
  v_exp_f32 v30, v30
  v_cvt_pk_bf16_f32 v122, v28, v29
  v_exp_f32 v31, v31
  v_exp_f32 v32, v32
  v_cvt_pk_bf16_f32 v123, v30, v31
  v_exp_f32 v33, v33
  v_exp_f32 v34, v34
  v_mfma_f32_32x32x16_bf16 v[88:103], v[144:147], v[120:123], v[88:103]
  v_cvt_pk_bf16_f32 v124, v32, v33
  v_exp_f32 v35, v35
  v_exp_f32 v36, v36
  v_cvt_pk_bf16_f32 v125, v34, v35
  v_exp_f32 v37, v37
  v_exp_f32 v38, v38
  v_cvt_pk_bf16_f32 v126, v36, v37
  v_exp_f32 v39, v39
  v_exp_f32 v40, v40
  v_cvt_pk_bf16_f32 v127, v38, v39
  s_waitcnt lgkmcnt(0)
  v_mfma_f32_32x32x16_bf16 v[24:39], v[152:155], v[16:19], v[56:71]
  v_exp_f32 v41, v41
  v_exp_f32 v42, v42
  v_cvt_pk_bf16_f32 v120, v40, v41
  v_exp_f32 v43, v43
  v_exp_f32 v44, v44
  v_cvt_pk_bf16_f32 v121, v42, v43
  v_mfma_f32_32x32x16_bf16 v[88:103], v[148:151], v[124:127], v[88:103]
  v_exp_f32 v45, v45
  v_exp_f32 v46, v46
  v_cvt_pk_bf16_f32 v122, v44, v45
  v_exp_f32 v47, v47
  v_exp_f32 v48, v48
  v_cvt_pk_bf16_f32 v123, v46, v47
  v_exp_f32 v49, v49
  v_exp_f32 v50, v50
  v_mfma_f32_32x32x16_bf16 v[104:119], v[144:147], v[120:123], v[104:119]
  v_cvt_pk_bf16_f32 v124, v48, v49
  v_exp_f32 v51, v51
  v_exp_f32 v52, v52
  v_cvt_pk_bf16_f32 v125, v50, v51
  v_exp_f32 v53, v53
  v_exp_f32 v54, v54
  v_cvt_pk_bf16_f32 v126, v52, v53
  v_exp_f32 v55, v55
  v_exp_f32 v24, v24
  v_cvt_pk_bf16_f32 v127, v54, v55
  v_mfma_f32_32x32x16_bf16 v[40:55], v[152:155], v[20:23], v[72:87]
  v_exp_f32 v25, v25
  v_exp_f32 v26, v26
  v_cvt_pk_bf16_f32 v120, v24, v25
  v_exp_f32 v27, v27
  v_exp_f32 v28, v28
  v_cvt_pk_bf16_f32 v121, v26, v27
  v_mfma_f32_32x32x16_bf16 v[104:119], v[148:151], v[124:127], v[104:119]
  ds_read_b128 v[128:131], v8 offset:20480
  s_mov_b64 exec, s[92:93]
  ds_read_b128 v[132:135], v9 offset:20480
  ds_read_b128 v[136:139], v9 offset:20992
  s_mov_b64 exec, -1
  v_exp_f32 v29, v29
  v_exp_f32 v30, v30
  v_cvt_pk_bf16_f32 v122, v28, v29
  v_exp_f32 v31, v31
  v_exp_f32 v32, v32
  v_cvt_pk_bf16_f32 v123, v30, v31
  v_exp_f32 v33, v33
  v_exp_f32 v34, v34
  v_mfma_f32_32x32x16_bf16 v[88:103], v[156:159], v[120:123], v[88:103]
  v_cvt_pk_bf16_f32 v124, v32, v33
  v_exp_f32 v35, v35
  v_exp_f32 v36, v36
  v_cvt_pk_bf16_f32 v125, v34, v35
  v_exp_f32 v37, v37
  v_exp_f32 v38, v38
  v_cvt_pk_bf16_f32 v126, v36, v37
  v_exp_f32 v39, v39
  v_exp_f32 v40, v40
  v_cvt_pk_bf16_f32 v127, v38, v39
  s_waitcnt lgkmcnt(0)
  v_mfma_f32_32x32x16_bf16 v[24:39], v[128:131], v[16:19], v[56:71]
  v_exp_f32 v41, v41
  v_exp_f32 v42, v42
  v_cvt_pk_bf16_f32 v120, v40, v41
  v_exp_f32 v43, v43
  v_exp_f32 v44, v44
  v_cvt_pk_bf16_f32 v121, v42, v43
  v_mfma_f32_32x32x16_bf16 v[88:103], v[160:163], v[124:127], v[88:103]
  v_exp_f32 v45, v45
  v_exp_f32 v46, v46
  v_cvt_pk_bf16_f32 v122, v44, v45
  v_exp_f32 v47, v47
  v_exp_f32 v48, v48
  v_cvt_pk_bf16_f32 v123, v46, v47
  v_exp_f32 v49, v49
  v_exp_f32 v50, v50
  v_mfma_f32_32x32x16_bf16 v[104:119], v[156:159], v[120:123], v[104:119]
  v_cvt_pk_bf16_f32 v124, v48, v49
  v_exp_f32 v51, v51
  v_exp_f32 v52, v52
  v_cvt_pk_bf16_f32 v125, v50, v51
  v_exp_f32 v53, v53
  v_exp_f32 v54, v54
  v_cvt_pk_bf16_f32 v126, v52, v53
  v_exp_f32 v55, v55
  s_waitcnt lgkmcnt(0)
  s_barrier
  v_exp_f32 v24, v24
  v_cvt_pk_bf16_f32 v127, v54, v55
  v_mfma_f32_32x32x16_bf16 v[40:55], v[128:131], v[20:23], v[72:87]
  v_exp_f32 v25, v25
  v_exp_f32 v26, v26
  v_cvt_pk_bf16_f32 v120, v24, v25
  v_exp_f32 v27, v27
  v_exp_f32 v28, v28
  v_cvt_pk_bf16_f32 v121, v26, v27
  v_mfma_f32_32x32x16_bf16 v[104:119], v[160:163], v[124:127], v[104:119]
  ds_read_b128 v[140:143], v8 offset:40960
  s_mov_b64 exec, s[92:93]
  ds_read_b128 v[144:147], v9 offset:40960
  ds_read_b128 v[148:151], v9 offset:41472
  s_mov_b64 exec, -1
  v_exp_f32 v29, v29
  v_exp_f32 v30, v30
  v_cvt_pk_bf16_f32 v122, v28, v29
  v_exp_f32 v31, v31
  v_exp_f32 v32, v32
  v_cvt_pk_bf16_f32 v123, v30, v31
  v_exp_f32 v33, v33
  v_exp_f32 v34, v34
  v_mfma_f32_32x32x16_bf16 v[88:103], v[132:135], v[120:123], v[88:103]
  v_cvt_pk_bf16_f32 v124, v32, v33
  v_exp_f32 v35, v35
  v_exp_f32 v36, v36
  v_cvt_pk_bf16_f32 v125, v34, v35
  v_exp_f32 v37, v37
  v_exp_f32 v38, v38
  v_cvt_pk_bf16_f32 v126, v36, v37
  v_exp_f32 v39, v39
  v_exp_f32 v40, v40
  v_cvt_pk_bf16_f32 v127, v38, v39
  s_waitcnt lgkmcnt(0)
  v_mfma_f32_32x32x16_bf16 v[24:39], v[140:143], v[16:19], v[56:71]
  v_exp_f32 v41, v41
  v_exp_f32 v42, v42
  v_cvt_pk_bf16_f32 v120, v40, v41
  v_exp_f32 v43, v43
  v_exp_f32 v44, v44
  v_cvt_pk_bf16_f32 v121, v42, v43
  v_mfma_f32_32x32x16_bf16 v[88:103], v[136:139], v[124:127], v[88:103]
  v_exp_f32 v45, v45
  v_exp_f32 v46, v46
  v_cvt_pk_bf16_f32 v122, v44, v45
  v_exp_f32 v47, v47
  v_exp_f32 v48, v48
  v_cvt_pk_bf16_f32 v123, v46, v47
  v_exp_f32 v49, v49
  v_exp_f32 v50, v50
  v_mfma_f32_32x32x16_bf16 v[104:119], v[132:135], v[120:123], v[104:119]
  v_cvt_pk_bf16_f32 v124, v48, v49
  v_exp_f32 v51, v51
  v_exp_f32 v52, v52
  v_cvt_pk_bf16_f32 v125, v50, v51
  v_exp_f32 v53, v53
  v_exp_f32 v54, v54
  v_cvt_pk_bf16_f32 v126, v52, v53
  v_exp_f32 v55, v55
  v_exp_f32 v24, v24
  v_cvt_pk_bf16_f32 v127, v54, v55
  v_mfma_f32_32x32x16_bf16 v[40:55], v[140:143], v[20:23], v[72:87]
  v_exp_f32 v25, v25
  v_exp_f32 v26, v26
  v_cvt_pk_bf16_f32 v120, v24, v25
  v_exp_f32 v27, v27
  v_exp_f32 v28, v28
  v_cvt_pk_bf16_f32 v121, v26, v27
  v_mfma_f32_32x32x16_bf16 v[104:119], v[136:139], v[124:127], v[104:119]
  ds_read_b128 v[152:155], v8 offset:43008
  s_mov_b64 exec, s[92:93]
  ds_read_b128 v[156:159], v9 offset:43008
  ds_read_b128 v[160:163], v9 offset:43520
  s_mov_b64 exec, -1
  v_exp_f32 v29, v29
  v_exp_f32 v30, v30
  v_cvt_pk_bf16_f32 v122, v28, v29
  v_exp_f32 v31, v31
  v_exp_f32 v32, v32
  v_cvt_pk_bf16_f32 v123, v30, v31
  v_exp_f32 v33, v33
  v_exp_f32 v34, v34
  v_mfma_f32_32x32x16_bf16 v[88:103], v[144:147], v[120:123], v[88:103]
  v_cvt_pk_bf16_f32 v124, v32, v33
  v_exp_f32 v35, v35
  v_exp_f32 v36, v36
  v_cvt_pk_bf16_f32 v125, v34, v35
  v_exp_f32 v37, v37
  v_exp_f32 v38, v38
  v_cvt_pk_bf16_f32 v126, v36, v37
  v_exp_f32 v39, v39
  v_exp_f32 v40, v40
  v_cvt_pk_bf16_f32 v127, v38, v39
  s_waitcnt lgkmcnt(0)
  v_mfma_f32_32x32x16_bf16 v[24:39], v[152:155], v[16:19], v[56:71]
  v_exp_f32 v41, v41
  v_exp_f32 v42, v42
  v_cvt_pk_bf16_f32 v120, v40, v41
  v_exp_f32 v43, v43
  v_exp_f32 v44, v44
  v_cvt_pk_bf16_f32 v121, v42, v43
  v_mfma_f32_32x32x16_bf16 v[88:103], v[148:151], v[124:127], v[88:103]
  v_exp_f32 v45, v45
  v_exp_f32 v46, v46
  v_cvt_pk_bf16_f32 v122, v44, v45
  v_exp_f32 v47, v47
  v_exp_f32 v48, v48
  v_cvt_pk_bf16_f32 v123, v46, v47
  v_exp_f32 v49, v49
  v_exp_f32 v50, v50
  v_mfma_f32_32x32x16_bf16 v[104:119], v[144:147], v[120:123], v[104:119]
  v_cvt_pk_bf16_f32 v124, v48, v49
  v_exp_f32 v51, v51
  v_exp_f32 v52, v52
  v_cvt_pk_bf16_f32 v125, v50, v51
  v_exp_f32 v53, v53
  v_exp_f32 v54, v54
  v_cvt_pk_bf16_f32 v126, v52, v53
  v_exp_f32 v55, v55
  s_waitcnt lgkmcnt(0)
  s_barrier
  v_exp_f32 v24, v24
  v_cvt_pk_bf16_f32 v127, v54, v55
  v_mfma_f32_32x32x16_bf16 v[40:55], v[152:155], v[20:23], v[72:87]
  v_exp_f32 v25, v25
  v_exp_f32 v26, v26
  v_cvt_pk_bf16_f32 v120, v24, v25
  v_exp_f32 v27, v27
  v_exp_f32 v28, v28
  v_cvt_pk_bf16_f32 v121, v26, v27
  v_mfma_f32_32x32x16_bf16 v[104:119], v[148:151], v[124:127], v[104:119]
  ds_read_b128 v[128:131], v8 offset:18432
  s_mov_b64 exec, s[92:93]
  ds_read_b128 v[132:135], v9 offset:18432
  ds_read_b128 v[136:139], v9 offset:18944
  s_mov_b64 exec, -1
  v_exp_f32 v29, v29
  v_exp_f32 v30, v30
  v_cvt_pk_bf16_f32 v122, v28, v29
  v_exp_f32 v31, v31
  v_exp_f32 v32, v32
  v_cvt_pk_bf16_f32 v123, v30, v31
  v_exp_f32 v33, v33
  v_exp_f32 v34, v34
  v_mfma_f32_32x32x16_bf16 v[88:103], v[156:159], v[120:123], v[88:103]
  v_cvt_pk_bf16_f32 v124, v32, v33
  v_exp_f32 v35, v35
  v_exp_f32 v36, v36
  v_cvt_pk_bf16_f32 v125, v34, v35
  v_exp_f32 v37, v37
  v_exp_f32 v38, v38
  v_cvt_pk_bf16_f32 v126, v36, v37
  v_exp_f32 v39, v39
  v_exp_f32 v40, v40
  v_cvt_pk_bf16_f32 v127, v38, v39
  s_waitcnt lgkmcnt(0)
  v_mfma_f32_32x32x16_bf16 v[24:39], v[128:131], v[16:19], v[56:71]
  v_exp_f32 v41, v41
  v_exp_f32 v42, v42
  v_cvt_pk_bf16_f32 v120, v40, v41
  v_exp_f32 v43, v43
  v_exp_f32 v44, v44
  v_cvt_pk_bf16_f32 v121, v42, v43
  v_mfma_f32_32x32x16_bf16 v[88:103], v[160:163], v[124:127], v[88:103]
  v_exp_f32 v45, v45
  v_exp_f32 v46, v46
  v_cvt_pk_bf16_f32 v122, v44, v45
  v_exp_f32 v47, v47
  v_exp_f32 v48, v48
  v_cvt_pk_bf16_f32 v123, v46, v47
  v_exp_f32 v49, v49
  v_exp_f32 v50, v50
  v_mfma_f32_32x32x16_bf16 v[104:119], v[156:159], v[120:123], v[104:119]
  v_cvt_pk_bf16_f32 v124, v48, v49
  v_exp_f32 v51, v51
  v_exp_f32 v52, v52
  v_cvt_pk_bf16_f32 v125, v50, v51
  v_exp_f32 v53, v53
  v_exp_f32 v54, v54
  v_cvt_pk_bf16_f32 v126, v52, v53
  v_exp_f32 v55, v55
  v_exp_f32 v24, v24
  v_cvt_pk_bf16_f32 v127, v54, v55
  v_mfma_f32_32x32x16_bf16 v[40:55], v[128:131], v[20:23], v[72:87]
  v_exp_f32 v25, v25
  v_exp_f32 v26, v26
  v_cvt_pk_bf16_f32 v120, v24, v25
  v_exp_f32 v27, v27
  v_exp_f32 v28, v28
  v_cvt_pk_bf16_f32 v121, v26, v27
  v_mfma_f32_32x32x16_bf16 v[104:119], v[160:163], v[124:127], v[104:119]
  ds_read_b128 v[140:143], v8 offset:20480
  s_mov_b64 exec, s[92:93]
  ds_read_b128 v[144:147], v9 offset:20480
  ds_read_b128 v[148:151], v9 offset:20992
  s_mov_b64 exec, -1
  v_exp_f32 v29, v29
  v_exp_f32 v30, v30
  v_cvt_pk_bf16_f32 v122, v28, v29
  v_exp_f32 v31, v31
  v_exp_f32 v32, v32
  v_cvt_pk_bf16_f32 v123, v30, v31
  v_exp_f32 v33, v33
  v_exp_f32 v34, v34
  v_mfma_f32_32x32x16_bf16 v[88:103], v[132:135], v[120:123], v[88:103]
  v_cvt_pk_bf16_f32 v124, v32, v33
  v_exp_f32 v35, v35
  v_exp_f32 v36, v36
  v_cvt_pk_bf16_f32 v125, v34, v35
  v_exp_f32 v37, v37
  v_exp_f32 v38, v38
  v_cvt_pk_bf16_f32 v126, v36, v37
  v_exp_f32 v39, v39
  v_exp_f32 v40, v40
  v_cvt_pk_bf16_f32 v127, v38, v39
  s_waitcnt lgkmcnt(0)
  v_mfma_f32_32x32x16_bf16 v[24:39], v[140:143], v[16:19], v[56:71]
  v_exp_f32 v41, v41
  v_exp_f32 v42, v42
  v_cvt_pk_bf16_f32 v120, v40, v41
  v_exp_f32 v43, v43
  v_exp_f32 v44, v44
  v_cvt_pk_bf16_f32 v121, v42, v43
  v_mfma_f32_32x32x16_bf16 v[88:103], v[136:139], v[124:127], v[88:103]
  v_exp_f32 v45, v45
  v_exp_f32 v46, v46
  v_cvt_pk_bf16_f32 v122, v44, v45
  v_exp_f32 v47, v47
  v_exp_f32 v48, v48
  v_cvt_pk_bf16_f32 v123, v46, v47
  v_exp_f32 v49, v49
  v_exp_f32 v50, v50
  v_mfma_f32_32x32x16_bf16 v[104:119], v[132:135], v[120:123], v[104:119]
  v_cvt_pk_bf16_f32 v124, v48, v49
  v_exp_f32 v51, v51
  v_exp_f32 v52, v52
  v_cvt_pk_bf16_f32 v125, v50, v51
  v_exp_f32 v53, v53
  v_exp_f32 v54, v54
  v_cvt_pk_bf16_f32 v126, v52, v53
  v_exp_f32 v55, v55
  s_waitcnt lgkmcnt(0)
  s_barrier
  v_exp_f32 v24, v24
  v_cvt_pk_bf16_f32 v127, v54, v55
  v_mfma_f32_32x32x16_bf16 v[40:55], v[140:143], v[20:23], v[72:87]
  v_exp_f32 v25, v25
  v_exp_f32 v26, v26
  v_cvt_pk_bf16_f32 v120, v24, v25
  v_exp_f32 v27, v27
  v_exp_f32 v28, v28
  v_cvt_pk_bf16_f32 v121, v26, v27
  v_mfma_f32_32x32x16_bf16 v[104:119], v[136:139], v[124:127], v[104:119]
  ds_read_b128 v[152:155], v8 offset:40960
  s_mov_b64 exec, s[92:93]
  ds_read_b128 v[156:159], v9 offset:40960
  ds_read_b128 v[160:163], v9 offset:41472
  s_mov_b64 exec, -1
  v_exp_f32 v29, v29
  v_exp_f32 v30, v30
  v_cvt_pk_bf16_f32 v122, v28, v29
  v_exp_f32 v31, v31
  v_exp_f32 v32, v32
  v_cvt_pk_bf16_f32 v123, v30, v31
  v_exp_f32 v33, v33
  v_exp_f32 v34, v34
  v_mfma_f32_32x32x16_bf16 v[88:103], v[144:147], v[120:123], v[88:103]
  v_cvt_pk_bf16_f32 v124, v32, v33
  v_exp_f32 v35, v35
  v_exp_f32 v36, v36
  v_cvt_pk_bf16_f32 v125, v34, v35
  v_exp_f32 v37, v37
  v_exp_f32 v38, v38
  v_cvt_pk_bf16_f32 v126, v36, v37
  v_exp_f32 v39, v39
  v_exp_f32 v40, v40
  v_cvt_pk_bf16_f32 v127, v38, v39
  s_waitcnt lgkmcnt(0)
  v_mfma_f32_32x32x16_bf16 v[24:39], v[152:155], v[16:19], v[56:71]
  v_exp_f32 v41, v41
  v_exp_f32 v42, v42
  v_cvt_pk_bf16_f32 v120, v40, v41
  v_exp_f32 v43, v43
  v_exp_f32 v44, v44
  v_cvt_pk_bf16_f32 v121, v42, v43
  v_mfma_f32_32x32x16_bf16 v[88:103], v[148:151], v[124:127], v[88:103]
  v_exp_f32 v45, v45
  v_exp_f32 v46, v46
  v_cvt_pk_bf16_f32 v122, v44, v45
  v_exp_f32 v47, v47
  v_exp_f32 v48, v48
  v_cvt_pk_bf16_f32 v123, v46, v47
  v_exp_f32 v49, v49
  v_exp_f32 v50, v50
  v_mfma_f32_32x32x16_bf16 v[104:119], v[144:147], v[120:123], v[104:119]
  v_cvt_pk_bf16_f32 v124, v48, v49
  v_exp_f32 v51, v51
  v_exp_f32 v52, v52
  v_cvt_pk_bf16_f32 v125, v50, v51
  v_exp_f32 v53, v53
  v_exp_f32 v54, v54
  v_cvt_pk_bf16_f32 v126, v52, v53
  v_exp_f32 v55, v55
  v_exp_f32 v24, v24
  v_cvt_pk_bf16_f32 v127, v54, v55
  v_mfma_f32_32x32x16_bf16 v[40:55], v[152:155], v[20:23], v[72:87]
  v_exp_f32 v25, v25
  v_exp_f32 v26, v26
  v_cvt_pk_bf16_f32 v120, v24, v25
  v_exp_f32 v27, v27
  v_exp_f32 v28, v28
  v_cvt_pk_bf16_f32 v121, v26, v27
  v_mfma_f32_32x32x16_bf16 v[104:119], v[148:151], v[124:127], v[104:119]
  v_exp_f32 v29, v29
  v_exp_f32 v30, v30
  v_cvt_pk_bf16_f32 v122, v28, v29
  v_exp_f32 v31, v31
  v_exp_f32 v32, v32
  v_cvt_pk_bf16_f32 v123, v30, v31
  v_exp_f32 v33, v33
  v_exp_f32 v34, v34
  v_mfma_f32_32x32x16_bf16 v[88:103], v[156:159], v[120:123], v[88:103]
  v_cvt_pk_bf16_f32 v124, v32, v33
  v_exp_f32 v35, v35
  v_exp_f32 v36, v36
  v_cvt_pk_bf16_f32 v125, v34, v35
  v_exp_f32 v37, v37
  v_exp_f32 v38, v38
  v_cvt_pk_bf16_f32 v126, v36, v37
  v_exp_f32 v39, v39
  v_exp_f32 v40, v40
  v_cvt_pk_bf16_f32 v127, v38, v39
  s_nop 0
  v_exp_f32 v41, v41
  v_exp_f32 v42, v42
  v_cvt_pk_bf16_f32 v120, v40, v41
  v_exp_f32 v43, v43
  v_exp_f32 v44, v44
  v_cvt_pk_bf16_f32 v121, v42, v43
  v_mfma_f32_32x32x16_bf16 v[88:103], v[160:163], v[124:127], v[88:103]
  v_exp_f32 v45, v45
  v_exp_f32 v46, v46
  v_cvt_pk_bf16_f32 v122, v44, v45
  v_exp_f32 v47, v47
  v_exp_f32 v48, v48
  v_cvt_pk_bf16_f32 v123, v46, v47
  v_exp_f32 v49, v49
  v_exp_f32 v50, v50
  v_mfma_f32_32x32x16_bf16 v[104:119], v[156:159], v[120:123], v[104:119]
  v_cvt_pk_bf16_f32 v124, v48, v49
  v_exp_f32 v51, v51
  v_exp_f32 v52, v52
  v_cvt_pk_bf16_f32 v125, v50, v51
  v_exp_f32 v53, v53
  v_exp_f32 v54, v54
  v_cvt_pk_bf16_f32 v126, v52, v53
  v_exp_f32 v55, v55
  s_nop 0
  v_cvt_pk_bf16_f32 v127, v54, v55
  ds_write_b128 v6, v[88:91]
  ds_write_b128 v6, v[92:95] offset:1024
  v_mfma_f32_32x32x16_bf16 v[104:119], v[160:163], v[124:127], v[104:119]
  ds_write_b32 v10, v96
  s_nop 10
  ds_write_b128 v6, v[104:107] offset:2048
  ds_write_b128 v6, v[108:111] offset:3072
  ds_write_b32 v10, v112 offset:128
  s_waitcnt lgkmcnt(0)
  s_barrier
  s_branch L_fin
L_P:
  s_setprio 3
  s_lshr_b32 s11, s87, 1
  s_lshl_b32 s11, s11, 3
  s_and_b32 s7, s88, 7
  s_add_u32 s11, s11, s7
  s_and_b32 s10, s87, 1
  s_lshl_b32 s10, s10, 2
  s_lshr_b32 s7, s88, 3
  s_add_u32 s10, s10, s7
  v_mul_u32_u24 v6, 3072, v8
  v_add_u32 v6, v6, v9
  v_and_b32 v13, 31, v0
  v_bfe_u32 v14, v0, 1, 3
  v_lshlrev_b32 v13, 7, v13
  v_lshrrev_b32 v15, 5, v0
  v_xor_b32 v14, v14, v15
  v_xor_b32 v156, 0, v14
  v_lshl_add_u32 v156, v156, 4, v13
  v_xor_b32 v157, 2, v14
  v_lshl_add_u32 v157, v157, 4, v13
  v_xor_b32 v158, 4, v14
  v_lshl_add_u32 v158, v158, 4, v13
  v_xor_b32 v159, 6, v14
  v_lshl_add_u32 v159, v159, 4, v13
  v_lshrrev_b32 v13, 5, v0
  v_bfe_u32 v14, v0, 2, 2
  v_lshl_add_u32 v9, v13, 3, v14
  v_lshlrev_b32 v9, 7, v9
  v_and_b32 v14, 2, v14
  v_bfe_u32 v13, v0, 4, 1
  v_xor_b32 v14, v14, v13
  v_lshl_add_u32 v9, v14, 5, v9
  v_and_b32 v14, 3, v0
  v_lshl_add_u32 v9, v14, 3, v9
  s_lshl_b32 s6, s79, 12
  v_add_u32 v152, s6, v156
  v_add_u32 v153, s6, v157
  v_add_u32 v154, s6, v158
  v_add_u32 v155, s6, v159
  s_lshl_b32 s6, s78, 6
  v_xor_b32 v8, s6, v9
  v_add_u32 v8, 65536, v8
  v_lshrrev_b32 v13, 1, v5
  v_xor_b32 v13, v13, v4
  v_lshlrev_b32 v14, 7, v5
  s_lshr_b32 s6, s4, 1
  s_lshl_b32 s6, s6, 11
  v_add_u32 v14, s6, v14
  v_lshl_add_u32 v160, v13, 4, v14
  v_xor_b32 v161, 64, v160
  v_lshlrev_b32 v162, 8, v4
  v_lshl_add_u32 v162, v5, 3, v162
  s_lshl_b32 s6, s78, 14
  s_add_u32 s6, s6, 131072
  v_add_u32 v162, s6, v162
  s_lshl_b32 s84, s5, 3
  s_add_u32 s84, s84, s4
  s_lshl_b32 s85, s84, 6
  s_add_u32 s85, s85, 524288
  s_lshl_b32 s39, s5, 1
  s_lshr_b32 s7, s4, 2
  s_add_u32 s39, s39, s7
  s_lshl_b32 s39, s39, 11
  s_bfe_u32 s7, s4, 0x10001
  s_add_u32 s8, s78, 8
  s_lshl_b32 s7, s7, s8
  s_add_u32 s39, s39, s7
  s_lshl_b32 s7, s78, 10
  s_add_u32 s39, s39, s7
  s_sub_u32 s8, 9, s78
  v_lshlrev_b32 v163, s8, v4
  v_lshl_add_u32 v163, v5, 4, v163
  s_mul_i32 s14, s86, 24576
  s_lshl_b32 s7, s10, 7
  s_add_u32 s14, s14, s7
  s_lshl_b32 s6, s11, 16
  s_lshl_b32 s7, s86, 13
  s_add_u32 s6, s6, s7
  s_mov_b32 s38, s6
  s_lshl_b32 s13, s86, 13
  s_lshl_b32 s7, s4, 7
  s_add_u32 s13, s13, s7
  s_waitcnt lgkmcnt(0)
  s_lshl_b32 s77, s11, 3
  s_add_u32 s77, s77, s10
  s_lshl_b32 s82, s11, 1
  s_add_u32 s82, s82, s79
  s_lshl_b32 s83, s82, 16
  s_lshl_b32 s82, s82, 15
  s_lshl_b32 s7, s10, 7
  s_add_u32 s83, s83, s7
  s_lshl_b32 s6, s78, 6
  s_add_u32 s83, s83, s6
  s_lshl_b32 s12, s86, 13
  s_add_u32 s12, s12, s7
  s_and_b32 s9, s87, 1
  s_lshl_b32 s9, s9, 9
  s_lshr_b32 s89, s87, 1
  s_lshl_b32 s89, s89, 19
  s_lshl_b32 s7, s88, 14
  s_add_u32 s89, s89, s7
  s_mul_i32 s90, s88, 24576
  s_add_u32 s90, s90, s9
  s_add_u32 s90, s90, s15
  s_sub_u32 s90, s90, 1024
  s_waitcnt lgkmcnt(0)
  s_mov_b64 s[40:41], s[16:17]
  s_mov_b32 s42, 2097152
  s_mov_b32 s43, 0x00020000
  s_mov_b64 s[44:45], s[18:19]
  s_mov_b32 s46, 1572864
  s_mov_b32 s47, 0x00020000
  s_mov_b64 s[64:65], s[34:35]
  s_mov_b32 s66, 256
  s_mov_b32 s67, 0x00020000
  s_mov_b64 s[60:61], s[36:37]
  s_mov_b32 s62, 8388608
  s_mov_b32 s63, 0x00020000
  s_mov_b64 s[68:69], s[32:33]
  s_mov_b32 s70, 4194304
  s_mov_b32 s71, 0x00020000
  s_mov_b64 s[72:73], s[30:31]
  s_mov_b32 s74, 524288
  s_mov_b32 s75, 0x00020000
  s_mov_b64 s[56:57], s[20:21]
  s_mov_b32 s58, 524288
  s_mov_b32 s59, 0x00020000
  s_bitcmp1_b32 s4, 0
  s_cbranch_scc1 L_pq
  s_barrier
  s_cmp_ge_u32 s3, 6
  s_cbranch_scc1 L_nkv
  buffer_load_dword v165, v164, s[64:67], 0 offen sc1
  ds_read_b128 v[24:27], v160 offset:0
  ds_read_b64_tr_b16 v[28:29], v162 offset:0
  ds_read_b64_tr_b16 v[30:31], v162 offset:128
  ds_read_b128 v[32:35], v161 offset:0
  ds_read_b64_tr_b16 v[36:37], v162 offset:1024
  ds_read_b64_tr_b16 v[38:39], v162 offset:1152
  ds_read_b128 v[40:43], v160 offset:8192
  ds_read_b64_tr_b16 v[44:45], v162 offset:2048
  ds_read_b64_tr_b16 v[46:47], v162 offset:2176
  ds_read_b128 v[48:51], v161 offset:8192
  ds_read_b64_tr_b16 v[52:53], v162 offset:3072
  ds_read_b64_tr_b16 v[54:55], v162 offset:3200
  ds_read_b128 v[56:59], v160 offset:16384
  ds_read_b64_tr_b16 v[60:61], v162 offset:4096
  ds_read_b64_tr_b16 v[62:63], v162 offset:4224
  s_cmp_eq_u32 s78, 0
  s_cbranch_scc0 L_kvv
  s_waitcnt lgkmcnt(12)
  v_mfma_f32_16x16x32_bf16 v[12:15], v[28:31], v[24:27], 0
  ds_read_b128 v[64:67], v161 offset:16384
  ds_read_b64_tr_b16 v[68:69], v162 offset:5120
  ds_read_b64_tr_b16 v[70:71], v162 offset:5248
  s_waitcnt lgkmcnt(12)
  v_mfma_f32_16x16x32_bf16 v[12:15], v[36:39], v[32:35], v[12:15]
  ds_read_b128 v[72:75], v160 offset:24576
  ds_read_b64_tr_b16 v[76:77], v162 offset:6144
  ds_read_b64_tr_b16 v[78:79], v162 offset:6272
  s_waitcnt lgkmcnt(12)
  v_mfma_f32_16x16x32_bf16 v[12:15], v[44:47], v[40:43], v[12:15]
  ds_read_b128 v[80:83], v161 offset:24576
  ds_read_b64_tr_b16 v[84:85], v162 offset:7168
  ds_read_b64_tr_b16 v[86:87], v162 offset:7296
  s_waitcnt lgkmcnt(12)
  v_mfma_f32_16x16x32_bf16 v[12:15], v[52:55], v[48:51], v[12:15]
  ds_read_b128 v[88:91], v160 offset:32768
  ds_read_b64_tr_b16 v[92:93], v162 offset:8192
  ds_read_b64_tr_b16 v[94:95], v162 offset:8320
  s_waitcnt lgkmcnt(12)
  v_mfma_f32_16x16x32_bf16 v[12:15], v[60:63], v[56:59], v[12:15]
  ds_read_b128 v[96:99], v161 offset:32768
  ds_read_b64_tr_b16 v[100:101], v162 offset:9216
  ds_read_b64_tr_b16 v[102:103], v162 offset:9344
  s_waitcnt lgkmcnt(12)
  v_mfma_f32_16x16x32_bf16 v[12:15], v[68:71], v[64:67], v[12:15]
  ds_read_b128 v[104:107], v160 offset:40960
  ds_read_b64_tr_b16 v[108:109], v162 offset:10240
  ds_read_b64_tr_b16 v[110:111], v162 offset:10368
  s_waitcnt lgkmcnt(12)
  v_mfma_f32_16x16x32_bf16 v[12:15], v[76:79], v[72:75], v[12:15]
  ds_read_b128 v[112:115], v161 offset:40960
  ds_read_b64_tr_b16 v[116:117], v162 offset:11264
  ds_read_b64_tr_b16 v[118:119], v162 offset:11392
  s_waitcnt lgkmcnt(12)
  v_mfma_f32_16x16x32_bf16 v[12:15], v[84:87], v[80:83], v[12:15]
  ds_read_b128 v[120:123], v160 offset:49152
  ds_read_b64_tr_b16 v[124:125], v162 offset:12288
  ds_read_b64_tr_b16 v[126:127], v162 offset:12416
  s_waitcnt lgkmcnt(12)
  v_mfma_f32_16x16x32_bf16 v[12:15], v[92:95], v[88:91], v[12:15]
  ds_read_b128 v[128:131], v161 offset:49152
  ds_read_b64_tr_b16 v[132:133], v162 offset:13312
  ds_read_b64_tr_b16 v[134:135], v162 offset:13440
  s_waitcnt lgkmcnt(12)
  v_mfma_f32_16x16x32_bf16 v[12:15], v[100:103], v[96:99], v[12:15]
  ds_read_b128 v[136:139], v160 offset:57344
  ds_read_b64_tr_b16 v[140:141], v162 offset:14336
  ds_read_b64_tr_b16 v[142:143], v162 offset:14464
  s_waitcnt lgkmcnt(12)
  v_mfma_f32_16x16x32_bf16 v[12:15], v[108:111], v[104:107], v[12:15]
  ds_read_b128 v[144:147], v161 offset:57344
  ds_read_b64_tr_b16 v[148:149], v162 offset:15360
  ds_read_b64_tr_b16 v[150:151], v162 offset:15488
  s_waitcnt lgkmcnt(12)
  v_mfma_f32_16x16x32_bf16 v[12:15], v[116:119], v[112:115], v[12:15]
  s_waitcnt lgkmcnt(9)
  v_mfma_f32_16x16x32_bf16 v[12:15], v[124:127], v[120:123], v[12:15]
  s_waitcnt lgkmcnt(6)
  v_mfma_f32_16x16x32_bf16 v[12:15], v[132:135], v[128:131], v[12:15]
  s_waitcnt lgkmcnt(3)
  v_mfma_f32_16x16x32_bf16 v[12:15], v[140:143], v[136:139], v[12:15]
  s_waitcnt lgkmcnt(0)
  v_mfma_f32_16x16x32_bf16 v[12:15], v[148:151], v[144:147], v[12:15]
  s_branch L_kvj
L_kvv:
  s_waitcnt lgkmcnt(12)
  v_mfma_f32_16x16x32_bf16 v[12:15], v[24:27], v[28:31], 0
  ds_read_b128 v[64:67], v161 offset:16384
  ds_read_b64_tr_b16 v[68:69], v162 offset:5120
  ds_read_b64_tr_b16 v[70:71], v162 offset:5248
  s_waitcnt lgkmcnt(12)
  v_mfma_f32_16x16x32_bf16 v[12:15], v[32:35], v[36:39], v[12:15]
  ds_read_b128 v[72:75], v160 offset:24576
  ds_read_b64_tr_b16 v[76:77], v162 offset:6144
  ds_read_b64_tr_b16 v[78:79], v162 offset:6272
  s_waitcnt lgkmcnt(12)
  v_mfma_f32_16x16x32_bf16 v[12:15], v[40:43], v[44:47], v[12:15]
  ds_read_b128 v[80:83], v161 offset:24576
  ds_read_b64_tr_b16 v[84:85], v162 offset:7168
  ds_read_b64_tr_b16 v[86:87], v162 offset:7296
  s_waitcnt lgkmcnt(12)
  v_mfma_f32_16x16x32_bf16 v[12:15], v[48:51], v[52:55], v[12:15]
  ds_read_b128 v[88:91], v160 offset:32768
  ds_read_b64_tr_b16 v[92:93], v162 offset:8192
  ds_read_b64_tr_b16 v[94:95], v162 offset:8320
  s_waitcnt lgkmcnt(12)
  v_mfma_f32_16x16x32_bf16 v[12:15], v[56:59], v[60:63], v[12:15]
  ds_read_b128 v[96:99], v161 offset:32768
  ds_read_b64_tr_b16 v[100:101], v162 offset:9216
  ds_read_b64_tr_b16 v[102:103], v162 offset:9344
  s_waitcnt lgkmcnt(12)
  v_mfma_f32_16x16x32_bf16 v[12:15], v[64:67], v[68:71], v[12:15]
  ds_read_b128 v[104:107], v160 offset:40960
  ds_read_b64_tr_b16 v[108:109], v162 offset:10240
  ds_read_b64_tr_b16 v[110:111], v162 offset:10368
  s_waitcnt lgkmcnt(12)
  v_mfma_f32_16x16x32_bf16 v[12:15], v[72:75], v[76:79], v[12:15]
  ds_read_b128 v[112:115], v161 offset:40960
  ds_read_b64_tr_b16 v[116:117], v162 offset:11264
  ds_read_b64_tr_b16 v[118:119], v162 offset:11392
  s_waitcnt lgkmcnt(12)
  v_mfma_f32_16x16x32_bf16 v[12:15], v[80:83], v[84:87], v[12:15]
  ds_read_b128 v[120:123], v160 offset:49152
  ds_read_b64_tr_b16 v[124:125], v162 offset:12288
  ds_read_b64_tr_b16 v[126:127], v162 offset:12416
  s_waitcnt lgkmcnt(12)
  v_mfma_f32_16x16x32_bf16 v[12:15], v[88:91], v[92:95], v[12:15]
  ds_read_b128 v[128:131], v161 offset:49152
  ds_read_b64_tr_b16 v[132:133], v162 offset:13312
  ds_read_b64_tr_b16 v[134:135], v162 offset:13440
  s_waitcnt lgkmcnt(12)
  v_mfma_f32_16x16x32_bf16 v[12:15], v[96:99], v[100:103], v[12:15]
  ds_read_b128 v[136:139], v160 offset:57344
  ds_read_b64_tr_b16 v[140:141], v162 offset:14336
  ds_read_b64_tr_b16 v[142:143], v162 offset:14464
  s_waitcnt lgkmcnt(12)
  v_mfma_f32_16x16x32_bf16 v[12:15], v[104:107], v[108:111], v[12:15]
  ds_read_b128 v[144:147], v161 offset:57344
  ds_read_b64_tr_b16 v[148:149], v162 offset:15360
  ds_read_b64_tr_b16 v[150:151], v162 offset:15488
  s_waitcnt lgkmcnt(12)
  v_mfma_f32_16x16x32_bf16 v[12:15], v[112:115], v[116:119], v[12:15]
  s_waitcnt lgkmcnt(9)
  v_mfma_f32_16x16x32_bf16 v[12:15], v[120:123], v[124:127], v[12:15]
  s_waitcnt lgkmcnt(6)
  v_mfma_f32_16x16x32_bf16 v[12:15], v[128:131], v[132:135], v[12:15]
  s_waitcnt lgkmcnt(3)
  v_mfma_f32_16x16x32_bf16 v[12:15], v[136:139], v[140:143], v[12:15]
  s_waitcnt lgkmcnt(0)
  v_mfma_f32_16x16x32_bf16 v[12:15], v[144:147], v[148:151], v[12:15]
L_kvj:
  s_nop 6
  s_nop 0
  v_cvt_pk_bf16_f32 v16, v12, v13
  v_cvt_pk_bf16_f32 v17, v14, v15
  v_cvt_pk_bf16_f32 v18, v12, v13
  v_cvt_pk_bf16_f32 v19, v14, v15
  s_nop 0
  v_permlane32_swap_b32 v16, v18
  v_permlane32_swap_b32 v17, v19
  s_mov_b64 exec, 0xffffffff
  buffer_store_dwordx4 v[16:19], v163, s[60:63], s39 offen sc1
  s_mov_b64 exec, -1
L_nkv:
  s_cmp_lg_u32 s80, 0
  s_cbranch_scc1 L_pq
  s_waitcnt vmcnt(0)
  s_barrier
  s_cmp_lg_u32 s3, 4
  s_cbranch_scc1 L_pq
  v_cmp_eq_u32 vcc, 0, v165
  s_nop 4
  s_cbranch_vccz L_n4_x
  s_mov_b32 s7, 0
L_n4:
  buffer_load_dword v165, v164, s[64:67], 0 offen sc1
  s_waitcnt vmcnt(0)
  v_cmp_eq_u32 vcc, 0, v165
  s_add_u32 s7, s7, 1
  s_cmp_ge_u32 s7, 1048576
  s_cbranch_scc1 L_n4_x
  s_nop 1
  s_cbranch_vccnz L_n4
L_n4_x:
  v_readfirstlane_b32 s76, v165
  s_mov_b64 exec, 1
  buffer_store_dword v165, v164, s[60:63], s85 offen sc1
  s_mov_b64 exec, -1
L_pq:
  v_mov_b32 v132, v152
  v_mov_b32 v133, v153
  v_mov_b32 v134, v154
  v_mov_b32 v135, v155
  v_subrev_u32 v136, 57344, v8
  v_add_u32 v142, 65536, v132
  v_add_u32 v143, 65536, v133
  v_add_u32 v144, 65536, v134
  v_add_u32 v145, 65536, v135
  v_add_u32 v146, 65536, v136
  v_and_b32 v13, 3, v0
  v_lshlrev_b32 v13, 7, v13
  v_lshrrev_b32 v163, 2, v0
  v_lshl_add_u32 v162, v163, 10, v13
  v_mul_u32_u24 v163, 3072, v163
  v_add_u32 v163, v163, v13
  s_lshl_b32 s6, s86, 11
  s_add_u32 s6, s6, 0
  v_add_u32 v13, s6, v1
  v_lshrrev_b32 v10, 5, v0
  v_lshlrev_b32 v15, 4, v5
  v_lshl_add_u32 v15, v10, 8, v15
  s_lshl_b32 s39, s77, 13
  s_add_u32 s39, s39, 5242880
  v_and_b32 v12, 31, v0
  v_mul_u32_u24 v11, 272, v12
  v_lshl_add_u32 v11, v10, 4, v11
  s_mul_i32 s6, s79, 8704
  s_lshl_b32 s7, s78, 7
  s_add_u32 s6, s6, s7
  v_add_u32 v11, s6, v11
  v_mov_b32 v112, 0x3eb8aa3b
  s_barrier
  ds_read_b128 v[24:27], v152 offset:0
  ds_read_b64_tr_b16 v[28:29], v8 offset:0
  ds_read_b64_tr_b16 v[30:31], v8 offset:512
  ds_read_b128 v[32:35], v153 offset:0
  ds_read_b64_tr_b16 v[36:37], v8 offset:2048
  ds_read_b64_tr_b16 v[38:39], v8 offset:2560
  ds_read_b128 v[40:43], v154 offset:0
  ds_read_b64_tr_b16 v[44:45], v8 offset:4096
  ds_read_b64_tr_b16 v[46:47], v8 offset:4608
  ds_read_b128 v[48:51], v155 offset:0
  ds_read_b64_tr_b16 v[52:53], v8 offset:6144
  ds_read_b64_tr_b16 v[54:55], v8 offset:6656
  s_barrier
  s_waitcnt lgkmcnt(9)
  v_mfma_f32_32x32x16_bf16 v[96:111], v[28:31], v[24:27], 0
  ds_read_b128 v[56:59], v152 offset:8192
  ds_read_b64_tr_b16 v[60:61], v8 offset:8192
  ds_read_b64_tr_b16 v[62:63], v8 offset:8704
  s_waitcnt lgkmcnt(9)
  v_mfma_f32_32x32x16_bf16 v[96:111], v[36:39], v[32:35], v[96:111]
  ds_read_b128 v[64:67], v153 offset:8192
  ds_read_b64_tr_b16 v[68:69], v8 offset:10240
  ds_read_b64_tr_b16 v[70:71], v8 offset:10752
  s_waitcnt lgkmcnt(9)
  v_mfma_f32_32x32x16_bf16 v[96:111], v[44:47], v[40:43], v[96:111]
  ds_read_b128 v[72:75], v154 offset:8192
  ds_read_b64_tr_b16 v[76:77], v8 offset:12288
  ds_read_b64_tr_b16 v[78:79], v8 offset:12800
  s_waitcnt lgkmcnt(9)
  v_mfma_f32_32x32x16_bf16 v[96:111], v[52:55], v[48:51], v[96:111]
  ds_read_b128 v[80:83], v155 offset:8192
  ds_read_b64_tr_b16 v[84:85], v8 offset:14336
  ds_read_b64_tr_b16 v[86:87], v8 offset:14848
  ds_read_b128 v[24:27], v152 offset:16384
  s_waitcnt lgkmcnt(10)
  v_mfma_f32_32x32x16_bf16 v[96:111], v[60:63], v[56:59], v[96:111]
  ds_read_b64_tr_b16 v[28:29], v8 offset:16384
  ds_read_b64_tr_b16 v[30:31], v8 offset:16896
  ds_read_b128 v[32:35], v153 offset:16384
  s_waitcnt lgkmcnt(10)
  v_mfma_f32_32x32x16_bf16 v[96:111], v[68:71], v[64:67], v[96:111]
  ds_read_b64_tr_b16 v[36:37], v8 offset:18432
  ds_read_b64_tr_b16 v[38:39], v8 offset:18944
  ds_read_b128 v[40:43], v154 offset:16384
  s_waitcnt lgkmcnt(10)
  v_mfma_f32_32x32x16_bf16 v[96:111], v[76:79], v[72:75], v[96:111]
  ds_read_b64_tr_b16 v[44:45], v8 offset:20480
  ds_read_b64_tr_b16 v[46:47], v8 offset:20992
  s_waitcnt lgkmcnt(9)
  v_mfma_f32_32x32x16_bf16 v[96:111], v[84:87], v[80:83], v[96:111]
  ds_read_b128 v[48:51], v155 offset:16384
  ds_read_b64_tr_b16 v[52:53], v8 offset:22528
  ds_read_b64_tr_b16 v[54:55], v8 offset:23040
  s_barrier
  s_waitcnt lgkmcnt(9)
  v_mfma_f32_32x32x16_bf16 v[96:111], v[28:31], v[24:27], v[96:111]
  ds_read_b128 v[56:59], v152 offset:24576
  ds_read_b64_tr_b16 v[60:61], v8 offset:24576
  ds_read_b64_tr_b16 v[62:63], v8 offset:25088
  s_waitcnt lgkmcnt(9)
  v_mfma_f32_32x32x16_bf16 v[96:111], v[36:39], v[32:35], v[96:111]
  ds_read_b128 v[64:67], v153 offset:24576
  ds_read_b64_tr_b16 v[68:69], v8 offset:26624
  ds_read_b64_tr_b16 v[70:71], v8 offset:27136
  s_waitcnt lgkmcnt(9)
  v_mfma_f32_32x32x16_bf16 v[96:111], v[44:47], v[40:43], v[96:111]
  ds_read_b128 v[72:75], v154 offset:24576
  ds_read_b64_tr_b16 v[76:77], v8 offset:28672
  ds_read_b64_tr_b16 v[78:79], v8 offset:29184
  s_waitcnt lgkmcnt(9)
  v_mfma_f32_32x32x16_bf16 v[96:111], v[52:55], v[48:51], v[96:111]
  ds_read_b128 v[80:83], v155 offset:24576
  ds_read_b64_tr_b16 v[84:85], v8 offset:30720
  ds_read_b64_tr_b16 v[86:87], v8 offset:31232
  ds_read_b128 v[24:27], v152 offset:32768
  s_waitcnt lgkmcnt(10)
  v_mfma_f32_32x32x16_bf16 v[96:111], v[60:63], v[56:59], v[96:111]
  ds_read_b64_tr_b16 v[28:29], v8 offset:32768
  ds_read_b64_tr_b16 v[30:31], v8 offset:33280
  ds_read_b128 v[32:35], v153 offset:32768
  s_waitcnt lgkmcnt(10)
  v_mfma_f32_32x32x16_bf16 v[96:111], v[68:71], v[64:67], v[96:111]
  ds_read_b64_tr_b16 v[36:37], v8 offset:34816
  ds_read_b64_tr_b16 v[38:39], v8 offset:35328
  ds_read_b128 v[40:43], v154 offset:32768
  s_waitcnt lgkmcnt(10)
  v_mfma_f32_32x32x16_bf16 v[96:111], v[76:79], v[72:75], v[96:111]
  ds_read_b64_tr_b16 v[44:45], v8 offset:36864
  ds_read_b64_tr_b16 v[46:47], v8 offset:37376
  s_waitcnt lgkmcnt(9)
  v_mfma_f32_32x32x16_bf16 v[96:111], v[84:87], v[80:83], v[96:111]
  ds_read_b128 v[48:51], v155 offset:32768
  ds_read_b64_tr_b16 v[52:53], v8 offset:38912
  ds_read_b64_tr_b16 v[54:55], v8 offset:39424
  ds_read_b128 v[56:59], v152 offset:40960
  s_waitcnt lgkmcnt(10)
  v_mfma_f32_32x32x16_bf16 v[96:111], v[28:31], v[24:27], v[96:111]
  ds_read_b64_tr_b16 v[60:61], v8 offset:40960
  ds_read_b64_tr_b16 v[62:63], v8 offset:41472
  ds_read_b128 v[64:67], v153 offset:40960
  s_waitcnt lgkmcnt(10)
  v_mfma_f32_32x32x16_bf16 v[96:111], v[36:39], v[32:35], v[96:111]
  ds_read_b64_tr_b16 v[68:69], v8 offset:43008
  ds_read_b64_tr_b16 v[70:71], v8 offset:43520
  ds_read_b128 v[72:75], v154 offset:40960
  s_waitcnt lgkmcnt(10)
  v_mfma_f32_32x32x16_bf16 v[96:111], v[44:47], v[40:43], v[96:111]
  ds_read_b64_tr_b16 v[76:77], v8 offset:45056
  ds_read_b64_tr_b16 v[78:79], v8 offset:45568
  s_waitcnt lgkmcnt(9)
  v_mfma_f32_32x32x16_bf16 v[96:111], v[52:55], v[48:51], v[96:111]
  ds_read_b128 v[80:83], v155 offset:40960
  ds_read_b64_tr_b16 v[84:85], v8 offset:47104
  ds_read_b64_tr_b16 v[86:87], v8 offset:47616
  s_barrier
  s_waitcnt lgkmcnt(9)
  v_mfma_f32_32x32x16_bf16 v[96:111], v[60:63], v[56:59], v[96:111]
  ds_read_b128 v[24:27], v152 offset:49152
  ds_read_b64_tr_b16 v[28:29], v8 offset:49152
  ds_read_b64_tr_b16 v[30:31], v8 offset:49664
  s_waitcnt lgkmcnt(9)
  v_mfma_f32_32x32x16_bf16 v[96:111], v[68:71], v[64:67], v[96:111]
  ds_read_b128 v[32:35], v153 offset:49152
  ds_read_b64_tr_b16 v[36:37], v8 offset:51200
  ds_read_b64_tr_b16 v[38:39], v8 offset:51712
  s_waitcnt lgkmcnt(9)
  v_mfma_f32_32x32x16_bf16 v[96:111], v[76:79], v[72:75], v[96:111]
  ds_read_b128 v[40:43], v154 offset:49152
  ds_read_b64_tr_b16 v[44:45], v8 offset:53248
  ds_read_b64_tr_b16 v[46:47], v8 offset:53760
  s_waitcnt lgkmcnt(9)
  v_mfma_f32_32x32x16_bf16 v[96:111], v[84:87], v[80:83], v[96:111]
  ds_read_b128 v[48:51], v155 offset:49152
  ds_read_b64_tr_b16 v[52:53], v8 offset:55296
  ds_read_b64_tr_b16 v[54:55], v8 offset:55808
  ds_read_b128 v[56:59], v152 offset:57344
  s_waitcnt lgkmcnt(10)
  v_mfma_f32_32x32x16_bf16 v[96:111], v[28:31], v[24:27], v[96:111]
  ds_read_b64_tr_b16 v[60:61], v8 offset:57344
  ds_read_b64_tr_b16 v[62:63], v8 offset:57856
  ds_read_b128 v[64:67], v153 offset:57344
  s_waitcnt lgkmcnt(10)
  v_mfma_f32_32x32x16_bf16 v[96:111], v[36:39], v[32:35], v[96:111]
  ds_read_b64_tr_b16 v[68:69], v8 offset:59392
  ds_read_b64_tr_b16 v[70:71], v8 offset:59904
  ds_read_b128 v[72:75], v154 offset:57344
  s_waitcnt lgkmcnt(10)
  v_mfma_f32_32x32x16_bf16 v[96:111], v[44:47], v[40:43], v[96:111]
  ds_read_b64_tr_b16 v[76:77], v8 offset:61440
  ds_read_b64_tr_b16 v[78:79], v8 offset:61952
  s_waitcnt lgkmcnt(9)
  v_mfma_f32_32x32x16_bf16 v[96:111], v[52:55], v[48:51], v[96:111]
  ds_read_b128 v[80:83], v155 offset:57344
  ds_read_b64_tr_b16 v[84:85], v8 offset:63488
  ds_read_b64_tr_b16 v[86:87], v8 offset:64000
  s_waitcnt lgkmcnt(9)
  v_mfma_f32_32x32x16_bf16 v[96:111], v[60:63], v[56:59], v[96:111]
  s_waitcnt lgkmcnt(6)
  v_mfma_f32_32x32x16_bf16 v[96:111], v[68:71], v[64:67], v[96:111]
  s_waitcnt lgkmcnt(3)
  v_mfma_f32_32x32x16_bf16 v[96:111], v[76:79], v[72:75], v[96:111]
  s_waitcnt lgkmcnt(0)
  v_mfma_f32_32x32x16_bf16 v[96:111], v[84:87], v[80:83], v[96:111]
  v_mov_b32 v8, v12
  v_mov_b64 v[24:25], 0
  v_mov_b64 v[26:27], 0
  v_mov_b64 v[28:29], 0
  v_mov_b64 v[30:31], 0
  v_mov_b64 v[32:33], 0
  v_mov_b64 v[34:35], 0
  v_mov_b64 v[36:37], 0
  v_mov_b64 v[38:39], 0
  v_mov_b64 v[40:41], 0
  v_mov_b64 v[42:43], 0
  s_nop 0
  v_pk_mul_f32 v[96:97], v[96:97], v[112:113] op_sel_hi:[1,0]
  v_pk_mul_f32 v[98:99], v[98:99], v[112:113] op_sel_hi:[1,0]
  v_pk_mul_f32 v[100:101], v[100:101], v[112:113] op_sel_hi:[1,0]
  v_pk_mul_f32 v[102:103], v[102:103], v[112:113] op_sel_hi:[1,0]
  v_pk_mul_f32 v[104:105], v[104:105], v[112:113] op_sel_hi:[1,0]
  v_pk_mul_f32 v[106:107], v[106:107], v[112:113] op_sel_hi:[1,0]
  v_pk_mul_f32 v[108:109], v[108:109], v[112:113] op_sel_hi:[1,0]
  v_pk_mul_f32 v[110:111], v[110:111], v[112:113] op_sel_hi:[1,0]
  v_cvt_pk_bf16_f32 v16, v96, v97
  v_cvt_pk_bf16_f32 v17, v98, v99
  v_cvt_pk_bf16_f32 v18, v100, v101
  v_cvt_pk_bf16_f32 v19, v102, v103
  v_cvt_pk_bf16_f32 v20, v104, v105
  v_cvt_pk_bf16_f32 v21, v106, v107
  v_cvt_pk_bf16_f32 v22, v108, v109
  v_cvt_pk_bf16_f32 v23, v110, v111
  ds_write_b128 v13, v[16:19]
  ds_write_b128 v13, v[20:23] offset:1024
  v_mov_b64 v[44:45], 0
  v_mov_b64 v[46:47], 0
  v_mov_b64 v[48:49], 0
  v_mov_b64 v[50:51], 0
  v_mov_b64 v[52:53], 0
  v_mov_b64 v[54:55], 0
  v_mov_b64 v[56:57], 0
  v_mov_b64 v[58:59], 0
  v_mov_b64 v[60:61], 0
  v_mov_b64 v[62:63], 0
  v_mov_b64 v[64:65], 0
  v_mov_b64 v[66:67], 0
  v_mov_b64 v[68:69], 0
  v_mov_b64 v[70:71], 0
  s_waitcnt vmcnt(0) lgkmcnt(0)
  v_mov_b32 v16, 163824
  v_mov_b32 v17, 1
  s_barrier
  ds_write_b32 v16, v164
  s_and_b32 s6, s4, 1
  s_xor_b32 s6, s6, s80
  s_cmp_eq_u32 s3, 4
  s_cselect_b32 s6, s6, 0
  s_cmp_eq_u32 s6, 0
  s_cbranch_scc1 L_nrf
  v_cmp_eq_u32 vcc, 0, v165
  s_nop 4
  s_cbranch_vccz L_n5_x
  s_mov_b32 s7, 0
L_n5:
  buffer_load_dword v165, v164, s[64:67], 0 offen sc1
  s_waitcnt vmcnt(0)
  v_cmp_eq_u32 vcc, 0, v165
  s_add_u32 s7, s7, 1
  s_cmp_ge_u32 s7, 1048576
  s_cbranch_scc1 L_n5_x
  s_nop 1
  s_cbranch_vccnz L_n5
L_n5_x:
  v_readfirstlane_b32 s76, v165
  s_mov_b64 exec, 1
  buffer_store_dword v165, v164, s[60:63], s85 offen sc1
  s_mov_b64 exec, -1
L_nrf:
  buffer_load_dword v165, v164, s[64:67], 0 offen sc1
  s_cmp_eq_u32 s3, 4
  s_cbranch_scc0 L_pa0a
  buffer_load_dword v19, v162, s[40:43], s89 offen offset:0
  s_branch L_pa0b
L_pa0a:
  s_add_u32 s6, s90, 0
  s_mov_b32 exec_hi, 0
  buffer_load_dword v19, v163, s[44:47], s6 offen
  s_mov_b32 exec_hi, -1
L_pa0b:
  s_waitcnt lgkmcnt(0)
  s_barrier
  s_mul_i32 s8, s86, 3200
  s_add_u32 s8, s8, 527872
  s_waitcnt vmcnt(1)
  v_cmp_eq_u32 vcc, 0, v165
  s_nop 4
  s_cbranch_vccz L_np_x
  s_mov_b32 s7, 0
L_np:
  buffer_load_dword v165, v164, s[64:67], 0 offen sc1
  s_waitcnt vmcnt(0)
  v_cmp_eq_u32 vcc, 0, v165
  s_add_u32 s7, s7, 1
  s_cmp_ge_u32 s7, 1048576
  s_cbranch_scc1 L_np_x
  s_nop 1
  s_cbranch_vccnz L_np
L_np_x:
  v_readfirstlane_b32 s76, v165
  s_mov_b64 exec, 0x1ffffff
  s_mov_b32 s7, 0
L_pg1:
  buffer_load_dword v20, v166, s[60:63], s8 offen sc1
  s_waitcnt vmcnt(0)
  v_cmp_ne_u32 vcc, s76, v20
  s_add_u32 s7, s7, 1
  s_cmp_ge_u32 s7, 1048576
  s_cbranch_scc1 L_pg1_x
  s_nop 1
  s_cbranch_vccnz L_pg1
L_pg1_x:
  s_mov_b64 exec, -1
  s_waitcnt lgkmcnt(0)
  s_mov_b64 exec, 1
  ds_add_u32 v16, v17
L_ps1:
  ds_read_b32 v18, v16
  s_waitcnt lgkmcnt(0)
  v_readfirstlane_b32 s6, v18
  s_nop 0
  s_cmp_ge_u32 s6, 4
  s_cbranch_scc0 L_ps1
  s_mov_b64 exec, -1
  s_add_u32 m0, s15, 32768
  s_add_u32 s6, s38, 0
  buffer_load_dwordx4 v2, s[40:43], s6 offen lds
  s_waitcnt vmcnt(4)
  s_add_u32 m0, s15, 36864
  s_add_u32 s6, s38, 32768
  buffer_load_dwordx4 v2, s[40:43], s6 offen lds
  s_waitcnt vmcnt(4)
  s_add_u32 m0, s15, 40960
  s_add_u32 s6, s14, 0
  buffer_load_dwordx4 v6, s[44:47], s6 offen lds
  s_waitcnt vmcnt(4)
  s_add_u32 m0, s15, 45056
  s_add_u32 s6, s14, 98304
  buffer_load_dwordx4 v6, s[44:47], s6 offen lds
  s_waitcnt vmcnt(4)
  s_add_u32 m0, s15, 49152
  s_add_u32 s6, s14, 1024
  buffer_load_dwordx4 v6, s[44:47], s6 offen lds
  s_waitcnt vmcnt(4)
  s_add_u32 m0, s15, 53248
  s_add_u32 s6, s14, 99328
  buffer_load_dwordx4 v6, s[44:47], s6 offen lds
  s_waitcnt vmcnt(4)
  s_add_u32 m0, s15, 57344
  s_add_u32 s6, s14, 2048
  buffer_load_dwordx4 v6, s[44:47], s6 offen lds
  s_waitcnt vmcnt(4)
  s_add_u32 m0, s15, 61440
  s_add_u32 s6, s14, 100352
  buffer_load_dwordx4 v6, s[44:47], s6 offen lds
  s_waitcnt vmcnt(4)
  s_cmp_lg_u32 s79, 0
  s_cbranch_scc1 L_gl1
  s_add_u32 m0, s15, 137216
  s_add_u32 s6, s15, 49152
  buffer_load_dwordx4 v1, s[60:63], s6 offen sc1 lds
L_gl1:
  s_waitcnt vmcnt(4)
  s_add_u32 m0, s15, 116736
  s_add_u32 s6, s15, 28672
  buffer_load_dwordx4 v1, s[60:63], s6 offen sc1 lds
  s_waitcnt vmcnt(4)
  s_add_u32 m0, s15, 120832
  s_add_u32 s6, s15, 32768
  buffer_load_dwordx4 v1, s[60:63], s6 offen sc1 lds
  s_waitcnt vmcnt(4)
  s_add_u32 m0, s15, 124928
  s_add_u32 s6, s15, 36864
  buffer_load_dwordx4 v1, s[60:63], s6 offen sc1 lds
  s_waitcnt vmcnt(4)
  s_add_u32 m0, s15, 129024
  s_add_u32 s6, s15, 40960
  buffer_load_dwordx4 v1, s[60:63], s6 offen sc1 lds
  s_waitcnt vmcnt(4)
  s_add_u32 m0, s15, 133120
  s_add_u32 s6, s15, 45056
  buffer_load_dwordx4 v1, s[60:63], s6 offen sc1 lds
  s_waitcnt vmcnt(4)
  s_add_u32 m0, s15, 65536
  s_add_u32 s6, s38, 128
  buffer_load_dwordx4 v2, s[40:43], s6 offen lds
  s_waitcnt vmcnt(6)
  s_add_u32 m0, s15, 69632
  s_add_u32 s6, s38, 32896
  buffer_load_dwordx4 v2, s[40:43], s6 offen lds
  s_waitcnt vmcnt(6)
  s_add_u32 m0, s15, 73728
  s_add_u32 s6, s14, 196608
  buffer_load_dwordx4 v6, s[44:47], s6 offen lds
  s_waitcnt vmcnt(6)
  s_add_u32 m0, s15, 77824
  s_add_u32 s6, s14, 294912
  buffer_load_dwordx4 v6, s[44:47], s6 offen lds
  s_waitcnt vmcnt(6)
  s_add_u32 m0, s15, 81920
  s_add_u32 s6, s14, 197632
  buffer_load_dwordx4 v6, s[44:47], s6 offen lds
  s_waitcnt vmcnt(6)
  s_add_u32 m0, s15, 86016
  s_add_u32 s6, s14, 295936
  buffer_load_dwordx4 v6, s[44:47], s6 offen lds
  s_waitcnt vmcnt(6)
  s_add_u32 m0, s15, 90112
  s_add_u32 s6, s14, 198656
  buffer_load_dwordx4 v6, s[44:47], s6 offen lds
  s_waitcnt vmcnt(6)
  s_add_u32 m0, s15, 94208
  s_add_u32 s6, s14, 296960
  buffer_load_dwordx4 v6, s[44:47], s6 offen lds
  s_waitcnt vmcnt(6)
  s_cmp_lg_u32 s3, 4
  s_cbranch_scc1 L_noid
  s_getreg_b32 s6, hwreg(HW_REG_XCC_ID)
  s_and_b32 s6, s6, 15
  s_or_b32 s6, s6, s76
  v_mov_b32 v20, s6
  s_lshl_b32 s6, s84, 2
  s_add_u32 s6, s6, 622592
  s_mov_b64 exec, 1
  buffer_store_dword v20, v164, s[60:63], s6 offen sc1
  s_mov_b64 exec, -1
L_noid:
  s_waitcnt vmcnt(13) lgkmcnt(0)
  s_mov_b64 exec, 1
  ds_add_u32 v16, v17
L_ps2:
  ds_read_b32 v18, v16
  s_waitcnt lgkmcnt(0)
  v_readfirstlane_b32 s6, v18
  s_nop 0
  s_cmp_ge_u32 s6, 8
  s_cbranch_scc0 L_ps2
  s_mov_b64 exec, -1
  ds_read_b128 v[88:91], v132 offset:32768
  ds_read_b64_tr_b16 v[92:93], v136 offset:32768
  ds_read_b64_tr_b16 v[94:95], v136 offset:33280
  ds_read_b64_tr_b16 v[96:97], v136 offset:40960
  ds_read_b64_tr_b16 v[98:99], v136 offset:41472
  s_waitcnt lgkmcnt(2)
  v_mfma_f32_32x32x16_bf16 v[24:39], v[92:95], v[88:91], v[24:39]
  s_add_u32 m0, s15, 0
  s_add_u32 s6, s38, 256
  buffer_load_dwordx4 v2, s[40:43], s6 offen lds
  ds_read_b64_tr_b16 v[100:101], v136 offset:49152
  ds_read_b64_tr_b16 v[102:103], v136 offset:49664
  s_waitcnt lgkmcnt(2)
  v_mfma_f32_32x32x16_bf16 v[40:55], v[96:99], v[88:91], v[40:55]
  s_add_u32 m0, s15, 4096
  s_add_u32 s6, s38, 33024
  buffer_load_dwordx4 v2, s[40:43], s6 offen lds
  ds_read_b128 v[104:107], v133 offset:32768
  ds_read_b64_tr_b16 v[108:109], v136 offset:34816
  ds_read_b64_tr_b16 v[110:111], v136 offset:35328
  s_waitcnt lgkmcnt(3)
  v_mfma_f32_32x32x16_bf16 v[56:71], v[100:103], v[88:91], v[56:71]
  s_add_u32 m0, s15, 8192
  s_add_u32 s6, s14, 393216
  buffer_load_dwordx4 v6, s[44:47], s6 offen lds
  ds_read_b64_tr_b16 v[112:113], v136 offset:43008
  ds_read_b64_tr_b16 v[114:115], v136 offset:43520
  s_waitcnt lgkmcnt(2)
  v_mfma_f32_32x32x16_bf16 v[24:39], v[108:111], v[104:107], v[24:39]
  s_add_u32 m0, s15, 12288
  s_add_u32 s6, s14, 491520
  buffer_load_dwordx4 v6, s[44:47], s6 offen lds
  ds_read_b64_tr_b16 v[116:117], v136 offset:51200
  ds_read_b64_tr_b16 v[118:119], v136 offset:51712
  s_waitcnt lgkmcnt(2)
  v_mfma_f32_32x32x16_bf16 v[40:55], v[112:115], v[104:107], v[40:55]
  s_add_u32 m0, s15, 16384
  s_add_u32 s6, s14, 394240
  buffer_load_dwordx4 v6, s[44:47], s6 offen lds
  ds_read_b128 v[88:91], v134 offset:32768
  ds_read_b64_tr_b16 v[92:93], v136 offset:36864
  ds_read_b64_tr_b16 v[94:95], v136 offset:37376
  s_waitcnt lgkmcnt(3)
  v_mfma_f32_32x32x16_bf16 v[56:71], v[116:119], v[104:107], v[56:71]
  s_add_u32 m0, s15, 20480
  s_add_u32 s6, s14, 492544
  buffer_load_dwordx4 v6, s[44:47], s6 offen lds
  ds_read_b64_tr_b16 v[96:97], v136 offset:45056
  ds_read_b64_tr_b16 v[98:99], v136 offset:45568
  s_waitcnt lgkmcnt(2)
  v_mfma_f32_32x32x16_bf16 v[24:39], v[92:95], v[88:91], v[24:39]
  s_add_u32 m0, s15, 24576
  s_add_u32 s6, s14, 395264
  buffer_load_dwordx4 v6, s[44:47], s6 offen lds
  ds_read_b64_tr_b16 v[100:101], v136 offset:53248
  ds_read_b64_tr_b16 v[102:103], v136 offset:53760
  s_waitcnt lgkmcnt(2)
  v_mfma_f32_32x32x16_bf16 v[40:55], v[96:99], v[88:91], v[40:55]
  s_add_u32 m0, s15, 28672
  s_add_u32 s6, s14, 493568
  buffer_load_dwordx4 v6, s[44:47], s6 offen lds
  ds_read_b128 v[104:107], v135 offset:32768
  ds_read_b64_tr_b16 v[108:109], v136 offset:38912
  ds_read_b64_tr_b16 v[110:111], v136 offset:39424
  s_waitcnt lgkmcnt(3)
  v_mfma_f32_32x32x16_bf16 v[56:71], v[100:103], v[88:91], v[56:71]
  s_cmp_eq_u32 s3, 4
  s_cbranch_scc0 L_pa1a
  buffer_load_dword v19, v162, s[40:43], s89 offen offset:512
  s_branch L_pa1b
L_pa1a:
  s_add_u32 s6, s90, 786432
  s_mov_b32 exec_hi, 0
  buffer_load_dword v19, v163, s[44:47], s6 offen
  s_mov_b32 exec_hi, -1
L_pa1b:
  ds_read_b64_tr_b16 v[112:113], v136 offset:47104
  ds_read_b64_tr_b16 v[114:115], v136 offset:47616
  s_waitcnt lgkmcnt(2)
  v_mfma_f32_32x32x16_bf16 v[24:39], v[108:111], v[104:107], v[24:39]
  s_waitcnt vmcnt(17) lgkmcnt(0)
  s_barrier
  ds_read_b64_tr_b16 v[116:117], v136 offset:55296
  ds_read_b64_tr_b16 v[118:119], v136 offset:55808
  s_waitcnt lgkmcnt(2)
  v_mfma_f32_32x32x16_bf16 v[40:55], v[112:115], v[104:107], v[40:55]
  s_cmp_lg_u32 s79, 0
  s_cbranch_scc1 L_gl2
  s_add_u32 m0, s15, 159744
  s_add_u32 s6, s15, 71680
  buffer_load_dwordx4 v1, s[60:63], s6 offen sc1 lds
L_gl2:
  s_waitcnt lgkmcnt(0)
  v_mfma_f32_32x32x16_bf16 v[56:71], v[116:119], v[104:107], v[56:71]
  s_add_u32 m0, s15, 139264
  s_add_u32 s6, s15, 51200
  buffer_load_dwordx4 v1, s[60:63], s6 offen sc1 lds
  s_add_u32 m0, s15, 143360
  s_add_u32 s6, s15, 55296
  buffer_load_dwordx4 v1, s[60:63], s6 offen sc1 lds
  s_add_u32 m0, s15, 147456
  s_add_u32 s6, s15, 59392
  buffer_load_dwordx4 v1, s[60:63], s6 offen sc1 lds
  s_add_u32 m0, s15, 151552
  s_add_u32 s6, s15, 63488
  buffer_load_dwordx4 v1, s[60:63], s6 offen sc1 lds
  s_add_u32 m0, s15, 155648
  s_add_u32 s6, s15, 67584
  buffer_load_dwordx4 v1, s[60:63], s6 offen sc1 lds
  s_waitcnt vmcnt(14) lgkmcnt(0)
  s_mov_b64 exec, 1
  ds_add_u32 v16, v17
L_ps3:
  ds_read_b32 v18, v16
  s_waitcnt lgkmcnt(0)
  v_readfirstlane_b32 s6, v18
  s_nop 0
  s_cmp_ge_u32 s6, 12
  s_cbranch_scc0 L_ps3
  s_mov_b64 exec, -1
  ds_read_b128 v[88:91], v142 offset:0
  ds_read_b64_tr_b16 v[92:93], v146 offset:0
  ds_read_b64_tr_b16 v[94:95], v146 offset:512
  ds_read_b64_tr_b16 v[96:97], v146 offset:8192
  ds_read_b64_tr_b16 v[98:99], v146 offset:8704
  s_waitcnt lgkmcnt(2)
  v_mfma_f32_32x32x16_bf16 v[24:39], v[92:95], v[88:91], v[24:39]
  s_add_u32 m0, s15, 32768
  s_add_u32 s6, s38, 384
  buffer_load_dwordx4 v2, s[40:43], s6 offen lds
  ds_read_b64_tr_b16 v[100:101], v146 offset:16384
  ds_read_b64_tr_b16 v[102:103], v146 offset:16896
  s_waitcnt lgkmcnt(2)
  v_mfma_f32_32x32x16_bf16 v[40:55], v[96:99], v[88:91], v[40:55]
  s_add_u32 m0, s15, 36864
  s_add_u32 s6, s38, 33152
  buffer_load_dwordx4 v2, s[40:43], s6 offen lds
  ds_read_b128 v[104:107], v143 offset:0
  ds_read_b64_tr_b16 v[108:109], v146 offset:2048
  ds_read_b64_tr_b16 v[110:111], v146 offset:2560
  s_waitcnt lgkmcnt(3)
  v_mfma_f32_32x32x16_bf16 v[56:71], v[100:103], v[88:91], v[56:71]
  s_add_u32 m0, s15, 40960
  s_add_u32 s6, s14, 589824
  buffer_load_dwordx4 v6, s[44:47], s6 offen lds
  ds_read_b64_tr_b16 v[112:113], v146 offset:10240
  ds_read_b64_tr_b16 v[114:115], v146 offset:10752
  s_waitcnt lgkmcnt(2)
  v_mfma_f32_32x32x16_bf16 v[24:39], v[108:111], v[104:107], v[24:39]
  s_add_u32 m0, s15, 45056
  s_add_u32 s6, s14, 688128
  buffer_load_dwordx4 v6, s[44:47], s6 offen lds
  ds_read_b64_tr_b16 v[116:117], v146 offset:18432
  ds_read_b64_tr_b16 v[118:119], v146 offset:18944
  s_waitcnt lgkmcnt(2)
  v_mfma_f32_32x32x16_bf16 v[40:55], v[112:115], v[104:107], v[40:55]
  s_add_u32 m0, s15, 49152
  s_add_u32 s6, s14, 590848
  buffer_load_dwordx4 v6, s[44:47], s6 offen lds
  ds_read_b128 v[88:91], v144 offset:0
  ds_read_b64_tr_b16 v[92:93], v146 offset:4096
  ds_read_b64_tr_b16 v[94:95], v146 offset:4608
  s_waitcnt lgkmcnt(3)
  v_mfma_f32_32x32x16_bf16 v[56:71], v[116:119], v[104:107], v[56:71]
  s_add_u32 m0, s15, 53248
  s_add_u32 s6, s14, 689152
  buffer_load_dwordx4 v6, s[44:47], s6 offen lds
  ds_read_b64_tr_b16 v[96:97], v146 offset:12288
  ds_read_b64_tr_b16 v[98:99], v146 offset:12800
  s_waitcnt lgkmcnt(2)
  v_mfma_f32_32x32x16_bf16 v[24:39], v[92:95], v[88:91], v[24:39]
  s_add_u32 m0, s15, 57344
  s_add_u32 s6, s14, 591872
  buffer_load_dwordx4 v6, s[44:47], s6 offen lds
  ds_read_b64_tr_b16 v[100:101], v146 offset:20480
  ds_read_b64_tr_b16 v[102:103], v146 offset:20992
  s_waitcnt lgkmcnt(2)
  v_mfma_f32_32x32x16_bf16 v[40:55], v[96:99], v[88:91], v[40:55]
  s_add_u32 m0, s15, 61440
  s_add_u32 s6, s14, 690176
  buffer_load_dwordx4 v6, s[44:47], s6 offen lds
  ds_read_b128 v[104:107], v145 offset:0
  ds_read_b64_tr_b16 v[108:109], v146 offset:6144
  ds_read_b64_tr_b16 v[110:111], v146 offset:6656
  s_waitcnt lgkmcnt(3)
  v_mfma_f32_32x32x16_bf16 v[56:71], v[100:103], v[88:91], v[56:71]
  ds_read_b64_tr_b16 v[112:113], v146 offset:14336
  ds_read_b64_tr_b16 v[114:115], v146 offset:14848
  s_waitcnt lgkmcnt(2)
  v_mfma_f32_32x32x16_bf16 v[24:39], v[108:111], v[104:107], v[24:39]
  ds_read_b64_tr_b16 v[116:117], v146 offset:22528
  ds_read_b64_tr_b16 v[118:119], v146 offset:23040
  s_waitcnt lgkmcnt(2)
  v_mfma_f32_32x32x16_bf16 v[40:55], v[112:115], v[104:107], v[40:55]
  s_waitcnt lgkmcnt(0)
  v_mfma_f32_32x32x16_bf16 v[56:71], v[116:119], v[104:107], v[56:71]
  s_waitcnt vmcnt(14) lgkmcnt(0)
  s_mov_b64 exec, 1
  ds_add_u32 v16, v17
L_ps4:
  ds_read_b32 v18, v16
  s_waitcnt lgkmcnt(0)
  v_readfirstlane_b32 s6, v18
  s_nop 0
  s_cmp_ge_u32 s6, 16
  s_cbranch_scc0 L_ps4
  s_mov_b64 exec, -1
  ds_read_b128 v[88:91], v132 offset:0
  ds_read_b64_tr_b16 v[92:93], v136 offset:0
  ds_read_b64_tr_b16 v[94:95], v136 offset:512
  ds_read_b64_tr_b16 v[96:97], v136 offset:8192
  ds_read_b64_tr_b16 v[98:99], v136 offset:8704
  s_waitcnt lgkmcnt(2)
  v_mfma_f32_32x32x16_bf16 v[24:39], v[92:95], v[88:91], v[24:39]
  s_add_u32 m0, s15, 65536
  s_add_u32 s6, s38, 512
  buffer_load_dwordx4 v2, s[40:43], s6 offen lds
  ds_read_b64_tr_b16 v[100:101], v136 offset:16384
  ds_read_b64_tr_b16 v[102:103], v136 offset:16896
  s_waitcnt lgkmcnt(2)
  v_mfma_f32_32x32x16_bf16 v[40:55], v[96:99], v[88:91], v[40:55]
  s_add_u32 m0, s15, 69632
  s_add_u32 s6, s38, 33280
  buffer_load_dwordx4 v2, s[40:43], s6 offen lds
  ds_read_b128 v[104:107], v133 offset:0
  ds_read_b64_tr_b16 v[108:109], v136 offset:2048
  ds_read_b64_tr_b16 v[110:111], v136 offset:2560
  s_waitcnt lgkmcnt(3)
  v_mfma_f32_32x32x16_bf16 v[56:71], v[100:103], v[88:91], v[56:71]
  s_add_u32 m0, s15, 73728
  s_add_u32 s6, s14, 786432
  buffer_load_dwordx4 v6, s[44:47], s6 offen lds
  ds_read_b64_tr_b16 v[112:113], v136 offset:10240
  ds_read_b64_tr_b16 v[114:115], v136 offset:10752
  s_waitcnt lgkmcnt(2)
  v_mfma_f32_32x32x16_bf16 v[24:39], v[108:111], v[104:107], v[24:39]
  s_add_u32 m0, s15, 77824
  s_add_u32 s6, s14, 884736
  buffer_load_dwordx4 v6, s[44:47], s6 offen lds
  ds_read_b64_tr_b16 v[116:117], v136 offset:18432
  ds_read_b64_tr_b16 v[118:119], v136 offset:18944
  s_waitcnt lgkmcnt(2)
  v_mfma_f32_32x32x16_bf16 v[40:55], v[112:115], v[104:107], v[40:55]
  s_add_u32 m0, s15, 81920
  s_add_u32 s6, s14, 787456
  buffer_load_dwordx4 v6, s[44:47], s6 offen lds
  ds_read_b128 v[88:91], v134 offset:0
  ds_read_b64_tr_b16 v[92:93], v136 offset:4096
  ds_read_b64_tr_b16 v[94:95], v136 offset:4608
  s_waitcnt lgkmcnt(3)
  v_mfma_f32_32x32x16_bf16 v[56:71], v[116:119], v[104:107], v[56:71]
  s_add_u32 m0, s15, 86016
  s_add_u32 s6, s14, 885760
  buffer_load_dwordx4 v6, s[44:47], s6 offen lds
  ds_read_b64_tr_b16 v[96:97], v136 offset:12288
  ds_read_b64_tr_b16 v[98:99], v136 offset:12800
  s_waitcnt lgkmcnt(2)
  v_mfma_f32_32x32x16_bf16 v[24:39], v[92:95], v[88:91], v[24:39]
  s_add_u32 m0, s15, 90112
  s_add_u32 s6, s14, 788480
  buffer_load_dwordx4 v6, s[44:47], s6 offen lds
  ds_read_b64_tr_b16 v[100:101], v136 offset:20480
  ds_read_b64_tr_b16 v[102:103], v136 offset:20992
  s_waitcnt lgkmcnt(2)
  v_mfma_f32_32x32x16_bf16 v[40:55], v[96:99], v[88:91], v[40:55]
  s_add_u32 m0, s15, 94208
  s_add_u32 s6, s14, 886784
  buffer_load_dwordx4 v6, s[44:47], s6 offen lds
  ds_read_b128 v[104:107], v135 offset:0
  ds_read_b64_tr_b16 v[108:109], v136 offset:6144
  ds_read_b64_tr_b16 v[110:111], v136 offset:6656
  s_waitcnt lgkmcnt(3)
  v_mfma_f32_32x32x16_bf16 v[56:71], v[100:103], v[88:91], v[56:71]
  ds_read_b64_tr_b16 v[112:113], v136 offset:14336
  ds_read_b64_tr_b16 v[114:115], v136 offset:14848
  s_waitcnt lgkmcnt(2)
  v_mfma_f32_32x32x16_bf16 v[24:39], v[108:111], v[104:107], v[24:39]
  ds_read_b64_tr_b16 v[116:117], v136 offset:22528
  ds_read_b64_tr_b16 v[118:119], v136 offset:23040
  s_waitcnt lgkmcnt(2)
  v_mfma_f32_32x32x16_bf16 v[40:55], v[112:115], v[104:107], v[40:55]
  s_waitcnt lgkmcnt(0)
  v_mfma_f32_32x32x16_bf16 v[56:71], v[116:119], v[104:107], v[56:71]
  s_waitcnt vmcnt(8) lgkmcnt(0)
  s_mov_b64 exec, 1
  ds_add_u32 v16, v17
L_ps5:
  ds_read_b32 v18, v16
  s_waitcnt lgkmcnt(0)
  v_readfirstlane_b32 s6, v18
  s_nop 0
  s_cmp_ge_u32 s6, 20
  s_cbranch_scc0 L_ps5
  s_mov_b64 exec, -1
  ds_read_b128 v[88:91], v132 offset:32768
  ds_read_b64_tr_b16 v[92:93], v136 offset:32768
  ds_read_b64_tr_b16 v[94:95], v136 offset:33280
  ds_read_b64_tr_b16 v[96:97], v136 offset:40960
  ds_read_b64_tr_b16 v[98:99], v136 offset:41472
  s_waitcnt lgkmcnt(2)
  v_mfma_f32_32x32x16_bf16 v[24:39], v[92:95], v[88:91], v[24:39]
  s_add_u32 m0, s15, 0
  s_add_u32 s6, s38, 640
  buffer_load_dwordx4 v2, s[40:43], s6 offen lds
  ds_read_b64_tr_b16 v[100:101], v136 offset:49152
  ds_read_b64_tr_b16 v[102:103], v136 offset:49664
  s_waitcnt lgkmcnt(2)
  v_mfma_f32_32x32x16_bf16 v[40:55], v[96:99], v[88:91], v[40:55]
  s_add_u32 m0, s15, 4096
  s_add_u32 s6, s38, 33408
  buffer_load_dwordx4 v2, s[40:43], s6 offen lds
  ds_read_b128 v[104:107], v133 offset:32768
  ds_read_b64_tr_b16 v[108:109], v136 offset:34816
  ds_read_b64_tr_b16 v[110:111], v136 offset:35328
  s_waitcnt lgkmcnt(3)
  v_mfma_f32_32x32x16_bf16 v[56:71], v[100:103], v[88:91], v[56:71]
  s_add_u32 m0, s15, 8192
  s_add_u32 s6, s14, 983040
  buffer_load_dwordx4 v6, s[44:47], s6 offen lds
  ds_read_b64_tr_b16 v[112:113], v136 offset:43008
  ds_read_b64_tr_b16 v[114:115], v136 offset:43520
  s_waitcnt lgkmcnt(2)
  v_mfma_f32_32x32x16_bf16 v[24:39], v[108:111], v[104:107], v[24:39]
  s_add_u32 m0, s15, 12288
  s_add_u32 s6, s14, 1081344
  buffer_load_dwordx4 v6, s[44:47], s6 offen lds
  ds_read_b64_tr_b16 v[116:117], v136 offset:51200
  ds_read_b64_tr_b16 v[118:119], v136 offset:51712
  s_waitcnt lgkmcnt(2)
  v_mfma_f32_32x32x16_bf16 v[40:55], v[112:115], v[104:107], v[40:55]
  s_add_u32 m0, s15, 16384
  s_add_u32 s6, s14, 984064
  buffer_load_dwordx4 v6, s[44:47], s6 offen lds
  ds_read_b128 v[88:91], v134 offset:32768
  ds_read_b64_tr_b16 v[92:93], v136 offset:36864
  ds_read_b64_tr_b16 v[94:95], v136 offset:37376
  s_waitcnt lgkmcnt(3)
  v_mfma_f32_32x32x16_bf16 v[56:71], v[116:119], v[104:107], v[56:71]
  s_add_u32 m0, s15, 20480
  s_add_u32 s6, s14, 1082368
  buffer_load_dwordx4 v6, s[44:47], s6 offen lds
  ds_read_b64_tr_b16 v[96:97], v136 offset:45056
  ds_read_b64_tr_b16 v[98:99], v136 offset:45568
  s_waitcnt lgkmcnt(2)
  v_mfma_f32_32x32x16_bf16 v[24:39], v[92:95], v[88:91], v[24:39]
  s_add_u32 m0, s15, 24576
  s_add_u32 s6, s14, 985088
  buffer_load_dwordx4 v6, s[44:47], s6 offen lds
  ds_read_b64_tr_b16 v[100:101], v136 offset:53248
  ds_read_b64_tr_b16 v[102:103], v136 offset:53760
  s_waitcnt lgkmcnt(2)
  v_mfma_f32_32x32x16_bf16 v[40:55], v[96:99], v[88:91], v[40:55]
  s_add_u32 m0, s15, 28672
  s_add_u32 s6, s14, 1083392
  buffer_load_dwordx4 v6, s[44:47], s6 offen lds
  ds_read_b128 v[104:107], v135 offset:32768
  ds_read_b64_tr_b16 v[108:109], v136 offset:38912
  ds_read_b64_tr_b16 v[110:111], v136 offset:39424
  s_waitcnt lgkmcnt(3)
  v_mfma_f32_32x32x16_bf16 v[56:71], v[100:103], v[88:91], v[56:71]
  ds_read_b64_tr_b16 v[112:113], v136 offset:47104
  ds_read_b64_tr_b16 v[114:115], v136 offset:47616
  s_waitcnt lgkmcnt(2)
  v_mfma_f32_32x32x16_bf16 v[24:39], v[108:111], v[104:107], v[24:39]
  ds_read_b64_tr_b16 v[116:117], v136 offset:55296
  ds_read_b64_tr_b16 v[118:119], v136 offset:55808
  s_waitcnt lgkmcnt(2)
  v_mfma_f32_32x32x16_bf16 v[40:55], v[112:115], v[104:107], v[40:55]
  s_waitcnt lgkmcnt(0)
  v_mfma_f32_32x32x16_bf16 v[56:71], v[116:119], v[104:107], v[56:71]
  s_waitcnt vmcnt(8) lgkmcnt(0)
  s_mov_b64 exec, 1
  ds_add_u32 v16, v17
L_ps6:
  ds_read_b32 v18, v16
  s_waitcnt lgkmcnt(0)
  v_readfirstlane_b32 s6, v18
  s_nop 0
  s_cmp_ge_u32 s6, 24
  s_cbranch_scc0 L_ps6
  s_mov_b64 exec, -1
  ds_read_b128 v[88:91], v142 offset:0
  ds_read_b64_tr_b16 v[92:93], v146 offset:0
  ds_read_b64_tr_b16 v[94:95], v146 offset:512
  ds_read_b64_tr_b16 v[96:97], v146 offset:8192
  ds_read_b64_tr_b16 v[98:99], v146 offset:8704
  s_waitcnt lgkmcnt(2)
  v_mfma_f32_32x32x16_bf16 v[24:39], v[92:95], v[88:91], v[24:39]
  s_add_u32 m0, s15, 32768
  s_add_u32 s6, s38, 768
  buffer_load_dwordx4 v2, s[40:43], s6 offen lds
  ds_read_b64_tr_b16 v[100:101], v146 offset:16384
  ds_read_b64_tr_b16 v[102:103], v146 offset:16896
  s_waitcnt lgkmcnt(2)
  v_mfma_f32_32x32x16_bf16 v[40:55], v[96:99], v[88:91], v[40:55]
  s_add_u32 m0, s15, 36864
  s_add_u32 s6, s38, 33536
  buffer_load_dwordx4 v2, s[40:43], s6 offen lds
  ds_read_b128 v[104:107], v143 offset:0
  ds_read_b64_tr_b16 v[108:109], v146 offset:2048
  ds_read_b64_tr_b16 v[110:111], v146 offset:2560
  s_waitcnt lgkmcnt(3)
  v_mfma_f32_32x32x16_bf16 v[56:71], v[100:103], v[88:91], v[56:71]
  s_add_u32 m0, s15, 40960
  s_add_u32 s6, s14, 1179648
  buffer_load_dwordx4 v6, s[44:47], s6 offen lds
  ds_read_b64_tr_b16 v[112:113], v146 offset:10240
  ds_read_b64_tr_b16 v[114:115], v146 offset:10752
  s_waitcnt lgkmcnt(2)
  v_mfma_f32_32x32x16_bf16 v[24:39], v[108:111], v[104:107], v[24:39]
  s_add_u32 m0, s15, 45056
  s_add_u32 s6, s14, 1277952
  buffer_load_dwordx4 v6, s[44:47], s6 offen lds
  ds_read_b64_tr_b16 v[116:117], v146 offset:18432
  ds_read_b64_tr_b16 v[118:119], v146 offset:18944
  s_waitcnt lgkmcnt(2)
  v_mfma_f32_32x32x16_bf16 v[40:55], v[112:115], v[104:107], v[40:55]
  s_add_u32 m0, s15, 49152
  s_add_u32 s6, s14, 1180672
  buffer_load_dwordx4 v6, s[44:47], s6 offen lds
  ds_read_b128 v[88:91], v144 offset:0
  ds_read_b64_tr_b16 v[92:93], v146 offset:4096
  ds_read_b64_tr_b16 v[94:95], v146 offset:4608
  s_waitcnt lgkmcnt(3)
  v_mfma_f32_32x32x16_bf16 v[56:71], v[116:119], v[104:107], v[56:71]
  s_add_u32 m0, s15, 53248
  s_add_u32 s6, s14, 1278976
  buffer_load_dwordx4 v6, s[44:47], s6 offen lds
  ds_read_b64_tr_b16 v[96:97], v146 offset:12288
  ds_read_b64_tr_b16 v[98:99], v146 offset:12800
  s_waitcnt lgkmcnt(2)
  v_mfma_f32_32x32x16_bf16 v[24:39], v[92:95], v[88:91], v[24:39]
  s_add_u32 m0, s15, 57344
  s_add_u32 s6, s14, 1181696
  buffer_load_dwordx4 v6, s[44:47], s6 offen lds
  ds_read_b64_tr_b16 v[100:101], v146 offset:20480
  ds_read_b64_tr_b16 v[102:103], v146 offset:20992
  s_waitcnt lgkmcnt(2)
  v_mfma_f32_32x32x16_bf16 v[40:55], v[96:99], v[88:91], v[40:55]
  s_add_u32 m0, s15, 61440
  s_add_u32 s6, s14, 1280000
  buffer_load_dwordx4 v6, s[44:47], s6 offen lds
  ds_read_b128 v[104:107], v145 offset:0
  ds_read_b64_tr_b16 v[108:109], v146 offset:6144
  ds_read_b64_tr_b16 v[110:111], v146 offset:6656
  s_waitcnt lgkmcnt(3)
  v_mfma_f32_32x32x16_bf16 v[56:71], v[100:103], v[88:91], v[56:71]
  ds_read_b64_tr_b16 v[112:113], v146 offset:14336
  ds_read_b64_tr_b16 v[114:115], v146 offset:14848
  s_waitcnt lgkmcnt(2)
  v_mfma_f32_32x32x16_bf16 v[24:39], v[108:111], v[104:107], v[24:39]
  ds_read_b64_tr_b16 v[116:117], v146 offset:22528
  ds_read_b64_tr_b16 v[118:119], v146 offset:23040
  s_waitcnt lgkmcnt(2)
  v_mfma_f32_32x32x16_bf16 v[40:55], v[112:115], v[104:107], v[40:55]
  s_waitcnt lgkmcnt(0)
  v_mfma_f32_32x32x16_bf16 v[56:71], v[116:119], v[104:107], v[56:71]
  s_waitcnt vmcnt(8) lgkmcnt(0)
  s_mov_b64 exec, 1
  ds_add_u32 v16, v17
L_ps7:
  ds_read_b32 v18, v16
  s_waitcnt lgkmcnt(0)
  v_readfirstlane_b32 s6, v18
  s_nop 0
  s_cmp_ge_u32 s6, 28
  s_cbranch_scc0 L_ps7
  s_mov_b64 exec, -1
  ds_read_b128 v[88:91], v132 offset:0
  ds_read_b64_tr_b16 v[92:93], v136 offset:0
  ds_read_b64_tr_b16 v[94:95], v136 offset:512
  ds_read_b64_tr_b16 v[96:97], v136 offset:8192
  ds_read_b64_tr_b16 v[98:99], v136 offset:8704
  s_waitcnt lgkmcnt(2)
  v_mfma_f32_32x32x16_bf16 v[24:39], v[92:95], v[88:91], v[24:39]
  s_add_u32 m0, s15, 65536
  s_add_u32 s6, s38, 896
  buffer_load_dwordx4 v2, s[40:43], s6 offen lds
  ds_read_b64_tr_b16 v[100:101], v136 offset:16384
  ds_read_b64_tr_b16 v[102:103], v136 offset:16896
  s_waitcnt lgkmcnt(2)
  v_mfma_f32_32x32x16_bf16 v[40:55], v[96:99], v[88:91], v[40:55]
  s_add_u32 m0, s15, 69632
  s_add_u32 s6, s38, 33664
  buffer_load_dwordx4 v2, s[40:43], s6 offen lds
  s_add_u32 m0, s15, 73728
  s_add_u32 s6, s14, 1376256
  buffer_load_dwordx4 v6, s[44:47], s6 offen lds
  s_add_u32 m0, s15, 77824
  s_add_u32 s6, s14, 1474560
  buffer_load_dwordx4 v6, s[44:47], s6 offen lds
  s_add_u32 m0, s15, 81920
  s_add_u32 s6, s14, 1377280
  buffer_load_dwordx4 v6, s[44:47], s6 offen lds
  s_add_u32 m0, s15, 86016
  s_add_u32 s6, s14, 1475584
  buffer_load_dwordx4 v6, s[44:47], s6 offen lds
  s_add_u32 m0, s15, 90112
  s_add_u32 s6, s14, 1378304
  buffer_load_dwordx4 v6, s[44:47], s6 offen lds
  s_add_u32 m0, s15, 94208
  s_add_u32 s6, s14, 1476608
  buffer_load_dwordx4 v6, s[44:47], s6 offen lds
  s_waitcnt vmcnt(40) lgkmcnt(0)
  s_barrier
  ds_read_b128 v[104:107], v133 offset:0
  ds_read_b64_tr_b16 v[108:109], v136 offset:2048
  ds_read_b64_tr_b16 v[110:111], v136 offset:2560
  s_waitcnt lgkmcnt(3)
  v_mfma_f32_32x32x16_bf16 v[56:71], v[100:103], v[88:91], v[56:71]
  s_cmp_lg_u32 s79, 0
  s_cbranch_scc1 L_gl3
  s_add_u32 m0, s15, 137216
  s_add_u32 s6, s15, 94208
  buffer_load_dwordx4 v1, s[60:63], s6 offen sc1 lds
L_gl3:
  ds_read_b64_tr_b16 v[112:113], v136 offset:10240
  ds_read_b64_tr_b16 v[114:115], v136 offset:10752
  s_waitcnt lgkmcnt(2)
  v_mfma_f32_32x32x16_bf16 v[24:39], v[108:111], v[104:107], v[24:39]
  s_add_u32 m0, s15, 116736
  s_add_u32 s6, s15, 73728
  buffer_load_dwordx4 v1, s[60:63], s6 offen sc1 lds
  ds_read_b64_tr_b16 v[116:117], v136 offset:18432
  ds_read_b64_tr_b16 v[118:119], v136 offset:18944
  s_waitcnt lgkmcnt(2)
  v_mfma_f32_32x32x16_bf16 v[40:55], v[112:115], v[104:107], v[40:55]
  s_add_u32 m0, s15, 120832
  s_add_u32 s6, s15, 77824
  buffer_load_dwordx4 v1, s[60:63], s6 offen sc1 lds
  ds_read_b128 v[88:91], v134 offset:0
  ds_read_b64_tr_b16 v[92:93], v136 offset:4096
  ds_read_b64_tr_b16 v[94:95], v136 offset:4608
  s_waitcnt lgkmcnt(3)
  v_mfma_f32_32x32x16_bf16 v[56:71], v[116:119], v[104:107], v[56:71]
  s_add_u32 m0, s15, 124928
  s_add_u32 s6, s15, 81920
  buffer_load_dwordx4 v1, s[60:63], s6 offen sc1 lds
  ds_read_b64_tr_b16 v[96:97], v136 offset:12288
  ds_read_b64_tr_b16 v[98:99], v136 offset:12800
  s_waitcnt lgkmcnt(2)
  v_mfma_f32_32x32x16_bf16 v[24:39], v[92:95], v[88:91], v[24:39]
  s_add_u32 m0, s15, 129024
  s_add_u32 s6, s15, 86016
  buffer_load_dwordx4 v1, s[60:63], s6 offen sc1 lds
  ds_read_b64_tr_b16 v[100:101], v136 offset:20480
  ds_read_b64_tr_b16 v[102:103], v136 offset:20992
  s_waitcnt lgkmcnt(2)
  v_mfma_f32_32x32x16_bf16 v[40:55], v[96:99], v[88:91], v[40:55]
  s_add_u32 m0, s15, 133120
  s_add_u32 s6, s15, 90112
  buffer_load_dwordx4 v1, s[60:63], s6 offen sc1 lds
  ds_read_b128 v[104:107], v135 offset:0
  ds_read_b64_tr_b16 v[108:109], v136 offset:6144
  ds_read_b64_tr_b16 v[110:111], v136 offset:6656
  s_waitcnt lgkmcnt(3)
  v_mfma_f32_32x32x16_bf16 v[56:71], v[100:103], v[88:91], v[56:71]
  ds_read_b64_tr_b16 v[112:113], v136 offset:14336
  ds_read_b64_tr_b16 v[114:115], v136 offset:14848
  s_waitcnt lgkmcnt(2)
  v_mfma_f32_32x32x16_bf16 v[24:39], v[108:111], v[104:107], v[24:39]
  ds_read_b64_tr_b16 v[116:117], v136 offset:22528
  ds_read_b64_tr_b16 v[118:119], v136 offset:23040
  s_waitcnt lgkmcnt(2)
  v_mfma_f32_32x32x16_bf16 v[40:55], v[112:115], v[104:107], v[40:55]
  s_waitcnt lgkmcnt(0)
  v_mfma_f32_32x32x16_bf16 v[56:71], v[116:119], v[104:107], v[56:71]
  s_waitcnt vmcnt(13) lgkmcnt(0)
  s_mov_b64 exec, 1
  ds_add_u32 v16, v17
L_ps8:
  ds_read_b32 v18, v16
  s_waitcnt lgkmcnt(0)
  v_readfirstlane_b32 s6, v18
  s_nop 0
  s_cmp_ge_u32 s6, 32
  s_cbranch_scc0 L_ps8
  s_mov_b64 exec, -1
  ds_read_b128 v[88:91], v132 offset:32768
  ds_read_b64_tr_b16 v[92:93], v136 offset:32768
  ds_read_b64_tr_b16 v[94:95], v136 offset:33280
  ds_read_b64_tr_b16 v[96:97], v136 offset:40960
  ds_read_b64_tr_b16 v[98:99], v136 offset:41472
  s_waitcnt lgkmcnt(2)
  v_mfma_f32_32x32x16_bf16 v[24:39], v[92:95], v[88:91], v[24:39]
  s_cmp_eq_u32 s3, 4
  s_cbranch_scc0 L_pw5
  s_lshl_b32 s6, s88, 14
  s_add_u32 s6, s6, s9
  buffer_load_dword v19, v162, s[56:59], s6 offen
L_pw5:
  s_cmp_lt_u32 s3, 6
  s_cbranch_scc1 L_pw6
  s_lshl_b32 s6, s88, 14
  s_lshl_b32 s7, s78, 13
  s_add_u32 s6, s6, s7
  buffer_load_dword v19, v166, s[72:75], s6 offen
L_pw6:
  s_cmp_lg_u32 s3, 5
  s_cbranch_scc1 L_ntch
  s_lshl_b32 s6, s84, 7
  s_add_u32 s6, s6, 589824
  buffer_load_dword v19, v164, s[60:63], s6 offen sc1
L_ntch:
  ds_read_b64_tr_b16 v[100:101], v136 offset:49152
  ds_read_b64_tr_b16 v[102:103], v136 offset:49664
  s_waitcnt lgkmcnt(2)
  v_mfma_f32_32x32x16_bf16 v[40:55], v[96:99], v[88:91], v[40:55]
  ds_read_b128 v[104:107], v133 offset:32768
  ds_read_b64_tr_b16 v[108:109], v136 offset:34816
  ds_read_b64_tr_b16 v[110:111], v136 offset:35328
  s_waitcnt lgkmcnt(3)
  v_mfma_f32_32x32x16_bf16 v[56:71], v[100:103], v[88:91], v[56:71]
  ds_read_b64_tr_b16 v[112:113], v136 offset:43008
  ds_read_b64_tr_b16 v[114:115], v136 offset:43520
  s_waitcnt lgkmcnt(2)
  v_mfma_f32_32x32x16_bf16 v[24:39], v[108:111], v[104:107], v[24:39]
  ds_read_b64_tr_b16 v[116:117], v136 offset:51200
  ds_read_b64_tr_b16 v[118:119], v136 offset:51712
  s_waitcnt lgkmcnt(2)
  v_mfma_f32_32x32x16_bf16 v[40:55], v[112:115], v[104:107], v[40:55]
  ds_read_b128 v[88:91], v134 offset:32768
  ds_read_b64_tr_b16 v[92:93], v136 offset:36864
  ds_read_b64_tr_b16 v[94:95], v136 offset:37376
  s_waitcnt lgkmcnt(3)
  v_mfma_f32_32x32x16_bf16 v[56:71], v[116:119], v[104:107], v[56:71]
  ds_read_b64_tr_b16 v[96:97], v136 offset:45056
  ds_read_b64_tr_b16 v[98:99], v136 offset:45568
  s_waitcnt lgkmcnt(2)
  v_mfma_f32_32x32x16_bf16 v[24:39], v[92:95], v[88:91], v[24:39]
  ds_read_b64_tr_b16 v[100:101], v136 offset:53248
  ds_read_b64_tr_b16 v[102:103], v136 offset:53760
  s_waitcnt lgkmcnt(2)
  v_mfma_f32_32x32x16_bf16 v[40:55], v[96:99], v[88:91], v[40:55]
  ds_read_b128 v[104:107], v135 offset:32768
  ds_read_b64_tr_b16 v[108:109], v136 offset:38912
  ds_read_b64_tr_b16 v[110:111], v136 offset:39424
  s_waitcnt lgkmcnt(3)
  v_mfma_f32_32x32x16_bf16 v[56:71], v[100:103], v[88:91], v[56:71]
  ds_read_b64_tr_b16 v[112:113], v136 offset:47104
  ds_read_b64_tr_b16 v[114:115], v136 offset:47616
  s_waitcnt lgkmcnt(2)
  v_mfma_f32_32x32x16_bf16 v[24:39], v[108:111], v[104:107], v[24:39]
  ds_read_b64_tr_b16 v[116:117], v136 offset:55296
  ds_read_b64_tr_b16 v[118:119], v136 offset:55808
  s_waitcnt lgkmcnt(2)
  v_mfma_f32_32x32x16_bf16 v[40:55], v[112:115], v[104:107], v[40:55]
  s_waitcnt lgkmcnt(0)
  v_mfma_f32_32x32x16_bf16 v[56:71], v[116:119], v[104:107], v[56:71]
  s_waitcnt vmcnt(5) lgkmcnt(0)
  s_mov_b64 exec, 1
  ds_add_u32 v16, v17
L_ps9:
  ds_read_b32 v18, v16
  s_waitcnt lgkmcnt(0)
  v_readfirstlane_b32 s6, v18
  s_nop 0
  s_cmp_ge_u32 s6, 36
  s_cbranch_scc0 L_ps9
  s_mov_b64 exec, -1
  ds_read_b128 v[88:91], v142 offset:0
  ds_read_b64_tr_b16 v[104:105], v146 offset:8192
  ds_read_b64_tr_b16 v[106:107], v146 offset:8704
  ds_read_b128 v[92:95], v143 offset:0
  ds_read_b64_tr_b16 v[108:109], v146 offset:10240
  ds_read_b64_tr_b16 v[110:111], v146 offset:10752
  s_waitcnt lgkmcnt(3)
  v_mfma_f32_32x32x16_bf16 v[40:55], v[104:107], v[88:91], v[40:55]
  ds_read_b128 v[96:99], v144 offset:0
  ds_read_b64_tr_b16 v[112:113], v146 offset:12288
  ds_read_b64_tr_b16 v[114:115], v146 offset:12800
  s_waitcnt lgkmcnt(3)
  v_mfma_f32_32x32x16_bf16 v[40:55], v[108:111], v[92:95], v[40:55]
  ds_read_b128 v[100:103], v145 offset:0
  ds_read_b64_tr_b16 v[116:117], v146 offset:14336
  ds_read_b64_tr_b16 v[118:119], v146 offset:14848
  s_waitcnt lgkmcnt(3)
  v_mfma_f32_32x32x16_bf16 v[40:55], v[112:115], v[96:99], v[40:55]
  ds_read_b64_tr_b16 v[104:105], v146 offset:16384
  ds_read_b64_tr_b16 v[106:107], v146 offset:16896
  s_waitcnt lgkmcnt(2)
  v_mfma_f32_32x32x16_bf16 v[40:55], v[116:119], v[100:103], v[40:55]
  ds_read_b64_tr_b16 v[108:109], v146 offset:18432
  ds_read_b64_tr_b16 v[110:111], v146 offset:18944
  s_waitcnt lgkmcnt(2)
  v_mfma_f32_32x32x16_bf16 v[56:71], v[104:107], v[88:91], v[56:71]
  ds_read_b64_tr_b16 v[112:113], v146 offset:20480
  ds_read_b64_tr_b16 v[114:115], v146 offset:20992
  s_waitcnt lgkmcnt(2)
  v_mfma_f32_32x32x16_bf16 v[56:71], v[108:111], v[92:95], v[56:71]
  s_cmp_eq_u32 s79, 0
  s_cbranch_scc1 L_hs1
  s_mov_b32 exec_lo, 0xffff0000
  s_mov_b32 exec_hi, 0xffff0000
  s_lshl_b32 s6, s78, 12
  s_add_u32 s6, s6, s39
  buffer_store_dwordx4 v[40:43], v15, s[60:63], s6 offen offset:0 sc1
  buffer_store_dwordx4 v[44:47], v15, s[60:63], s6 offen offset:512 sc1
  buffer_store_dwordx4 v[48:51], v15, s[60:63], s6 offen offset:1024 sc1
  buffer_store_dwordx4 v[52:55], v15, s[60:63], s6 offen offset:1536 sc1
  s_mov_b64 exec, -1
L_hs1:
  s_nop 1
  ds_write_b128 v11, v[40:43] offset:21760
  ds_read_b64_tr_b16 v[116:117], v146 offset:22528
  ds_read_b64_tr_b16 v[118:119], v146 offset:23040
  s_waitcnt lgkmcnt(2)
  v_mfma_f32_32x32x16_bf16 v[56:71], v[112:115], v[96:99], v[56:71]
  ds_write_b128 v11, v[44:47] offset:21792
  ds_read_b64_tr_b16 v[104:105], v146 offset:0
  ds_read_b64_tr_b16 v[106:107], v146 offset:512
  s_waitcnt lgkmcnt(2)
  v_mfma_f32_32x32x16_bf16 v[56:71], v[116:119], v[100:103], v[56:71]
  ds_write_b128 v11, v[48:51] offset:21824
  ds_read_b64_tr_b16 v[108:109], v146 offset:2048
  ds_read_b64_tr_b16 v[110:111], v146 offset:2560
  s_waitcnt lgkmcnt(2)
  v_mfma_f32_32x32x16_bf16 v[24:39], v[104:107], v[88:91], v[24:39]
  ds_write_b128 v11, v[52:55] offset:21856
  ds_read_b64_tr_b16 v[112:113], v146 offset:4096
  ds_read_b64_tr_b16 v[114:115], v146 offset:4608
  s_waitcnt lgkmcnt(2)
  v_mfma_f32_32x32x16_bf16 v[24:39], v[108:111], v[92:95], v[24:39]
  s_cmp_eq_u32 s79, 0
  s_cbranch_scc1 L_hs2
  s_mov_b32 exec_lo, 0xffff0000
  s_mov_b32 exec_hi, 0xffff0000
  s_lshl_b32 s6, s78, 12
  s_add_u32 s6, s6, s39
  buffer_store_dwordx4 v[56:59], v15, s[60:63], s6 offen offset:2048 sc1
  buffer_store_dwordx4 v[60:63], v15, s[60:63], s6 offen offset:2560 sc1
  buffer_store_dwordx4 v[64:67], v15, s[60:63], s6 offen offset:3072 sc1
  buffer_store_dwordx4 v[68:71], v15, s[60:63], s6 offen offset:3584 sc1
  s_mov_b64 exec, -1
L_hs2:
  ds_write_b128 v11, v[56:59] offset:43520
  ds_read_b64_tr_b16 v[116:117], v146 offset:6144
  ds_read_b64_tr_b16 v[118:119], v146 offset:6656
  s_waitcnt lgkmcnt(2)
  v_mfma_f32_32x32x16_bf16 v[24:39], v[112:115], v[96:99], v[24:39]
  ds_write_b128 v11, v[60:63] offset:43552
  s_waitcnt lgkmcnt(0)
  v_mfma_f32_32x32x16_bf16 v[24:39], v[116:119], v[100:103], v[24:39]
  ds_write_b128 v11, v[64:67] offset:43584
  ds_write_b128 v11, v[68:71] offset:43616
  s_waitcnt lgkmcnt(1)
  s_nop 8
  ds_write_b128 v11, v[24:27] offset:0
  s_waitcnt lgkmcnt(1)
  ds_write_b128 v11, v[28:31] offset:32
  s_waitcnt lgkmcnt(1)
  ds_write_b128 v11, v[32:35] offset:64
  s_waitcnt lgkmcnt(1)
  ds_write_b128 v11, v[36:39] offset:96
  s_waitcnt lgkmcnt(1)
  s_cmp_eq_u32 s79, 0
  s_cbranch_scc1 L_nhf
  s_lshl_b32 s6, s77, 1
  s_add_u32 s6, s6, s78
  s_lshl_b32 s6, s6, 7
  s_add_u32 s6, s6, 655360
  v_mov_b32 v20, s76
  s_waitcnt vmcnt(0)
  s_mov_b64 exec, 1
  buffer_store_dword v20, v164, s[60:63], s6 offen sc1
  s_mov_b64 exec, -1
L_nhf:
  s_waitcnt vmcnt(0) lgkmcnt(0)
  s_barrier
  s_cmp_lg_u32 s78, 0
  s_cbranch_scc1 L_nhalo
  v_mul_u32_u24 v13, 272, v5
  v_lshl_add_u32 v13, v4, 4, v13
  s_lshl_b32 s8, s79, 7
  v_add_u32 v13, s8, v13
  v_mov_b64 v[24:25], 0
  v_mov_b64 v[26:27], 0
  v_mov_b64 v[28:29], 0
  v_mov_b64 v[30:31], 0
  v_mov_b64 v[32:33], 0
  v_mov_b64 v[34:35], 0
  v_mov_b64 v[36:37], 0
  v_mov_b64 v[38:39], 0
  s_cmp_eq_u32 s11, 0
  s_cbranch_scc1 L_hz
  s_sub_u32 s6, s77, 8
  s_lshl_b32 s6, s6, 1
  s_add_u32 s6, s6, s79
  s_lshl_b32 s6, s6, 7
  s_add_u32 s6, s6, 655360
  s_mov_b64 exec, 1
  s_mov_b32 s7, 0
L_phl:
  buffer_load_dword v20, v164, s[60:63], s6 offen sc1
  s_waitcnt vmcnt(0)
  v_cmp_ne_u32 vcc, s76, v20
  s_add_u32 s7, s7, 1
  s_cmp_ge_u32 s7, 1048576
  s_cbranch_scc1 L_phl_x
  s_nop 1
  s_cbranch_vccnz L_phl
L_phl_x:
  s_mov_b64 exec, -1
  s_lshl_b32 s6, s79, 12
  s_add_u32 s6, s6, s39
  s_sub_u32 s6, s6, 65536
  buffer_load_dwordx4 v[24:27], v1, s[60:63], s6 offen offset:0 sc1
  buffer_load_dwordx4 v[28:31], v1, s[60:63], s6 offen offset:1024 sc1
  buffer_load_dwordx4 v[32:35], v1, s[60:63], s6 offen offset:2048 sc1
  buffer_load_dwordx4 v[36:39], v1, s[60:63], s6 offen offset:3072 sc1
  s_waitcnt vmcnt(0)
L_hz:
  ds_write_b128 v13, v[24:27] offset:17408
  ds_write_b128 v13, v[28:31] offset:17472
  ds_write_b128 v13, v[32:35] offset:39168
  ds_write_b128 v13, v[36:39] offset:39232
L_nhalo:
  s_lshl_b32 s6, s78, 5
  v_add_u32 v8, s6, v8
  v_mul_u32_u24 v9, 272, v8
  v_lshl_add_u32 v9, v10, 6, v9
  s_lshl_b32 s6, s79, 7
  s_add_u32 s6, s6, 0
  v_add_u32 v9, s6, v9
  ds_read_b128 v[24:27], v9 offset:0
  ds_read_b128 v[28:31], v9 offset:16
  ds_read_b128 v[32:35], v9 offset:32
  ds_read_b128 v[36:39], v9 offset:48
  ds_read_b128 v[40:43], v9 offset:21760
  ds_read_b128 v[44:47], v9 offset:21776
  ds_read_b128 v[48:51], v9 offset:21792
  ds_read_b128 v[52:55], v9 offset:21808
  ds_read_b128 v[56:59], v9 offset:21216
  ds_read_b128 v[60:63], v9 offset:21232
  ds_read_b128 v[64:67], v9 offset:21248
  ds_read_b128 v[68:71], v9 offset:21264
  ds_read_b128 v[72:75], v9 offset:20672
  ds_read_b128 v[76:79], v9 offset:20688
  ds_read_b128 v[80:83], v9 offset:20704
  ds_read_b128 v[84:87], v9 offset:20720
  s_add_u32 m0, s15, 139264
  s_add_u32 s6, s15, 96256
  buffer_load_dwordx4 v1, s[60:63], s6 offen sc1 lds
  s_waitcnt lgkmcnt(8)
  v_pk_mul_f32 v[136:137], v[24:25], v[40:41]
  v_pk_fma_f32 v[136:137], v[26:27], v[42:43], v[136:137]
  v_pk_fma_f32 v[136:137], v[28:29], v[44:45], v[136:137]
  v_pk_fma_f32 v[136:137], v[30:31], v[46:47], v[136:137]
  v_pk_fma_f32 v[136:137], v[32:33], v[48:49], v[136:137]
  v_pk_fma_f32 v[136:137], v[34:35], v[50:51], v[136:137]
  v_pk_fma_f32 v[136:137], v[36:37], v[52:53], v[136:137]
  v_pk_fma_f32 v[136:137], v[38:39], v[54:55], v[136:137]
  ds_read_b128 v[40:43], v9 offset:20128
  ds_read_b128 v[44:47], v9 offset:20144
  ds_read_b128 v[48:51], v9 offset:20160
  ds_read_b128 v[52:55], v9 offset:20176
  s_add_u32 m0, s15, 143360
  s_add_u32 s6, s15, 100352
  buffer_load_dwordx4 v1, s[60:63], s6 offen sc1 lds
  s_waitcnt lgkmcnt(8)
  v_pk_mul_f32 v[138:139], v[24:25], v[56:57]
  v_pk_fma_f32 v[138:139], v[26:27], v[58:59], v[138:139]
  v_pk_fma_f32 v[138:139], v[28:29], v[60:61], v[138:139]
  v_pk_fma_f32 v[138:139], v[30:31], v[62:63], v[138:139]
  v_pk_fma_f32 v[138:139], v[32:33], v[64:65], v[138:139]
  v_pk_fma_f32 v[138:139], v[34:35], v[66:67], v[138:139]
  v_pk_fma_f32 v[138:139], v[36:37], v[68:69], v[138:139]
  v_pk_fma_f32 v[138:139], v[38:39], v[70:71], v[138:139]
  ds_read_b128 v[56:59], v9 offset:19584
  ds_read_b128 v[60:63], v9 offset:19600
  ds_read_b128 v[64:67], v9 offset:19616
  ds_read_b128 v[68:71], v9 offset:19632
  s_add_u32 m0, s15, 147456
  s_add_u32 s6, s15, 104448
  buffer_load_dwordx4 v1, s[60:63], s6 offen sc1 lds
  s_waitcnt lgkmcnt(8)
  v_pk_mul_f32 v[140:141], v[24:25], v[72:73]
  v_pk_fma_f32 v[140:141], v[26:27], v[74:75], v[140:141]
  v_pk_fma_f32 v[140:141], v[28:29], v[76:77], v[140:141]
  v_pk_fma_f32 v[140:141], v[30:31], v[78:79], v[140:141]
  v_pk_fma_f32 v[140:141], v[32:33], v[80:81], v[140:141]
  v_pk_fma_f32 v[140:141], v[34:35], v[82:83], v[140:141]
  v_pk_fma_f32 v[140:141], v[36:37], v[84:85], v[140:141]
  v_pk_fma_f32 v[140:141], v[38:39], v[86:87], v[140:141]
  ds_read_b128 v[72:75], v9 offset:19040
  ds_read_b128 v[76:79], v9 offset:19056
  ds_read_b128 v[80:83], v9 offset:19072
  ds_read_b128 v[84:87], v9 offset:19088
  s_add_u32 m0, s15, 151552
  s_add_u32 s6, s15, 108544
  buffer_load_dwordx4 v1, s[60:63], s6 offen sc1 lds
  s_waitcnt lgkmcnt(8)
  v_pk_mul_f32 v[142:143], v[24:25], v[40:41]
  v_pk_fma_f32 v[142:143], v[26:27], v[42:43], v[142:143]
  v_pk_fma_f32 v[142:143], v[28:29], v[44:45], v[142:143]
  v_pk_fma_f32 v[142:143], v[30:31], v[46:47], v[142:143]
  v_pk_fma_f32 v[142:143], v[32:33], v[48:49], v[142:143]
  v_pk_fma_f32 v[142:143], v[34:35], v[50:51], v[142:143]
  v_pk_fma_f32 v[142:143], v[36:37], v[52:53], v[142:143]
  v_pk_fma_f32 v[142:143], v[38:39], v[54:55], v[142:143]
  ds_read_b128 v[40:43], v9 offset:18496
  ds_read_b128 v[44:47], v9 offset:18512
  ds_read_b128 v[48:51], v9 offset:18528
  ds_read_b128 v[52:55], v9 offset:18544
  s_add_u32 m0, s15, 155648
  s_add_u32 s6, s15, 112640
  buffer_load_dwordx4 v1, s[60:63], s6 offen sc1 lds
  s_waitcnt lgkmcnt(8)
  v_pk_mul_f32 v[144:145], v[24:25], v[56:57]
  v_pk_fma_f32 v[144:145], v[26:27], v[58:59], v[144:145]
  v_pk_fma_f32 v[144:145], v[28:29], v[60:61], v[144:145]
  v_pk_fma_f32 v[144:145], v[30:31], v[62:63], v[144:145]
  v_pk_fma_f32 v[144:145], v[32:33], v[64:65], v[144:145]
  v_pk_fma_f32 v[144:145], v[34:35], v[66:67], v[144:145]
  v_pk_fma_f32 v[144:145], v[36:37], v[68:69], v[144:145]
  v_pk_fma_f32 v[144:145], v[38:39], v[70:71], v[144:145]
  ds_read_b128 v[56:59], v9 offset:17952
  ds_read_b128 v[60:63], v9 offset:17968
  ds_read_b128 v[64:67], v9 offset:17984
  ds_read_b128 v[68:71], v9 offset:18000
  s_add_u32 m0, s15, 65536
  s_add_u32 s6, s13, 0
  buffer_load_dwordx4 v3, s[72:75], s6 offen lds
  s_waitcnt lgkmcnt(8)
  v_pk_mul_f32 v[146:147], v[24:25], v[72:73]
  v_pk_fma_f32 v[146:147], v[26:27], v[74:75], v[146:147]
  v_pk_fma_f32 v[146:147], v[28:29], v[76:77], v[146:147]
  v_pk_fma_f32 v[146:147], v[30:31], v[78:79], v[146:147]
  v_pk_fma_f32 v[146:147], v[32:33], v[80:81], v[146:147]
  v_pk_fma_f32 v[146:147], v[34:35], v[82:83], v[146:147]
  v_pk_fma_f32 v[146:147], v[36:37], v[84:85], v[146:147]
  v_pk_fma_f32 v[146:147], v[38:39], v[86:87], v[146:147]
  ds_read_b128 v[88:91], v9 offset:43520
  ds_read_b128 v[92:95], v9 offset:43536
  ds_read_b128 v[96:99], v9 offset:43552
  ds_read_b128 v[100:103], v9 offset:43568
  s_add_u32 m0, s15, 69632
  s_add_u32 s6, s13, 32768
  buffer_load_dwordx4 v3, s[72:75], s6 offen lds
  s_waitcnt lgkmcnt(8)
  v_pk_mul_f32 v[148:149], v[24:25], v[40:41]
  v_pk_fma_f32 v[148:149], v[26:27], v[42:43], v[148:149]
  v_pk_fma_f32 v[148:149], v[28:29], v[44:45], v[148:149]
  v_pk_fma_f32 v[148:149], v[30:31], v[46:47], v[148:149]
  v_pk_fma_f32 v[148:149], v[32:33], v[48:49], v[148:149]
  v_pk_fma_f32 v[148:149], v[34:35], v[50:51], v[148:149]
  v_pk_fma_f32 v[148:149], v[36:37], v[52:53], v[148:149]
  v_pk_fma_f32 v[148:149], v[38:39], v[54:55], v[148:149]
  ds_read_b128 v[104:107], v9 offset:42976
  ds_read_b128 v[108:111], v9 offset:42992
  ds_read_b128 v[112:115], v9 offset:43008
  ds_read_b128 v[116:119], v9 offset:43024
  s_add_u32 m0, s15, 73728
  s_add_u32 s6, s13, 65536
  buffer_load_dwordx4 v3, s[72:75], s6 offen lds
  s_waitcnt lgkmcnt(8)
  v_pk_mul_f32 v[150:151], v[24:25], v[56:57]
  v_pk_fma_f32 v[150:151], v[26:27], v[58:59], v[150:151]
  v_pk_fma_f32 v[150:151], v[28:29], v[60:61], v[150:151]
  v_pk_fma_f32 v[150:151], v[30:31], v[62:63], v[150:151]
  v_pk_fma_f32 v[150:151], v[32:33], v[64:65], v[150:151]
  v_pk_fma_f32 v[150:151], v[34:35], v[66:67], v[150:151]
  v_pk_fma_f32 v[150:151], v[36:37], v[68:69], v[150:151]
  v_pk_fma_f32 v[150:151], v[38:39], v[70:71], v[150:151]
  v_add_f32 v152, v136, v137
  v_add_f32 v153, v138, v139
  v_add_f32 v154, v140, v141
  v_add_f32 v155, v142, v143
  v_add_f32 v156, v144, v145
  v_add_f32 v157, v146, v147
  v_add_f32 v158, v148, v149
  v_add_f32 v159, v150, v151
  s_cmp_lg_u32 s11, 0
  s_cbranch_scc1 L_nomask
  v_mov_b32 v11, 0xcf6e6b28
  v_cmp_le_u32 vcc, 2, v8
  s_nop 1
  v_cndmask_b32 v153, v11, v153, vcc
  v_cmp_le_u32 vcc, 4, v8
  s_nop 1
  v_cndmask_b32 v154, v11, v154, vcc
  v_cmp_le_u32 vcc, 6, v8
  s_nop 1
  v_cndmask_b32 v155, v11, v155, vcc
  v_cmp_le_u32 vcc, 8, v8
  s_nop 1
  v_cndmask_b32 v156, v11, v156, vcc
  v_cmp_le_u32 vcc, 10, v8
  s_nop 1
  v_cndmask_b32 v157, v11, v157, vcc
  v_cmp_le_u32 vcc, 12, v8
  s_nop 1
  v_cndmask_b32 v158, v11, v158, vcc
  v_cmp_le_u32 vcc, 14, v8
  s_nop 1
  v_cndmask_b32 v159, v11, v159, vcc
L_nomask:
  v_max3_f32 v11, v152, v153, v154
  v_max3_f32 v11, v11, v155, v156
  v_max3_f32 v11, v11, v157, v158
  v_max_f32 v11, v11, v159
  s_mov_b32 s6, 0x3eb8aa3b
  v_sub_f32 v152, v152, v11
  v_sub_f32 v153, v153, v11
  v_sub_f32 v154, v154, v11
  v_sub_f32 v155, v155, v11
  v_sub_f32 v156, v156, v11
  v_sub_f32 v157, v157, v11
  v_sub_f32 v158, v158, v11
  v_sub_f32 v159, v159, v11
  v_mul_f32 v152, s6, v152
  v_mul_f32 v153, s6, v153
  v_mul_f32 v154, s6, v154
  v_mul_f32 v155, s6, v155
  v_mul_f32 v156, s6, v156
  v_mul_f32 v157, s6, v157
  v_mul_f32 v158, s6, v158
  v_mul_f32 v159, s6, v159
  v_exp_f32 v152, v152
  v_exp_f32 v153, v153
  v_exp_f32 v154, v154
  v_exp_f32 v155, v155
  v_exp_f32 v156, v156
  v_exp_f32 v157, v157
  v_exp_f32 v158, v158
  v_exp_f32 v159, v159
  v_add_f32 v11, v152, v153
  v_add_f32 v11, v11, v154
  v_add_f32 v11, v11, v155
  v_add_f32 v11, v11, v156
  v_add_f32 v11, v11, v157
  v_add_f32 v11, v11, v158
  v_add_f32 v11, v11, v159
  v_rcp_f32 v14, v11
  ds_read_b128 v[120:123], v9 offset:42432
  ds_read_b128 v[124:127], v9 offset:42448
  ds_read_b128 v[128:131], v9 offset:42464
  ds_read_b128 v[132:135], v9 offset:42480
  s_add_u32 m0, s15, 77824
  s_add_u32 s6, s13, 98304
  buffer_load_dwordx4 v3, s[72:75], s6 offen lds
  s_waitcnt lgkmcnt(8)
  v_pk_mul_f32 v[24:25], v[88:89], v[152:153] op_sel_hi:[1,0]
  v_pk_mul_f32 v[26:27], v[90:91], v[152:153] op_sel_hi:[1,0]
  v_pk_mul_f32 v[28:29], v[92:93], v[152:153] op_sel_hi:[1,0]
  v_pk_mul_f32 v[30:31], v[94:95], v[152:153] op_sel_hi:[1,0]
  v_pk_mul_f32 v[32:33], v[96:97], v[152:153] op_sel_hi:[1,0]
  v_pk_mul_f32 v[34:35], v[98:99], v[152:153] op_sel_hi:[1,0]
  v_pk_mul_f32 v[36:37], v[100:101], v[152:153] op_sel_hi:[1,0]
  v_pk_mul_f32 v[38:39], v[102:103], v[152:153] op_sel_hi:[1,0]
  ds_read_b128 v[88:91], v9 offset:41888
  ds_read_b128 v[92:95], v9 offset:41904
  ds_read_b128 v[96:99], v9 offset:41920
  ds_read_b128 v[100:103], v9 offset:41936
  s_add_u32 m0, s15, 81920
  s_add_u32 s6, s13, 131072
  buffer_load_dwordx4 v3, s[72:75], s6 offen lds
  s_waitcnt lgkmcnt(8)
  v_pk_fma_f32 v[24:25], v[104:105], v[152:153], v[24:25] op_sel:[0,1,0] op_sel_hi:[1,1,1]
  v_pk_fma_f32 v[26:27], v[106:107], v[152:153], v[26:27] op_sel:[0,1,0] op_sel_hi:[1,1,1]
  v_pk_fma_f32 v[28:29], v[108:109], v[152:153], v[28:29] op_sel:[0,1,0] op_sel_hi:[1,1,1]
  v_pk_fma_f32 v[30:31], v[110:111], v[152:153], v[30:31] op_sel:[0,1,0] op_sel_hi:[1,1,1]
  v_pk_fma_f32 v[32:33], v[112:113], v[152:153], v[32:33] op_sel:[0,1,0] op_sel_hi:[1,1,1]
  v_pk_fma_f32 v[34:35], v[114:115], v[152:153], v[34:35] op_sel:[0,1,0] op_sel_hi:[1,1,1]
  v_pk_fma_f32 v[36:37], v[116:117], v[152:153], v[36:37] op_sel:[0,1,0] op_sel_hi:[1,1,1]
  v_pk_fma_f32 v[38:39], v[118:119], v[152:153], v[38:39] op_sel:[0,1,0] op_sel_hi:[1,1,1]
  ds_read_b128 v[104:107], v9 offset:41344
  ds_read_b128 v[108:111], v9 offset:41360
  ds_read_b128 v[112:115], v9 offset:41376
  ds_read_b128 v[116:119], v9 offset:41392
  s_add_u32 m0, s15, 86016
  s_add_u32 s6, s13, 163840
  buffer_load_dwordx4 v3, s[72:75], s6 offen lds
  s_waitcnt lgkmcnt(8)
  v_pk_fma_f32 v[24:25], v[120:121], v[154:155], v[24:25] op_sel_hi:[1,0,1]
  v_pk_fma_f32 v[26:27], v[122:123], v[154:155], v[26:27] op_sel_hi:[1,0,1]
  v_pk_fma_f32 v[28:29], v[124:125], v[154:155], v[28:29] op_sel_hi:[1,0,1]
  v_pk_fma_f32 v[30:31], v[126:127], v[154:155], v[30:31] op_sel_hi:[1,0,1]
  v_pk_fma_f32 v[32:33], v[128:129], v[154:155], v[32:33] op_sel_hi:[1,0,1]
  v_pk_fma_f32 v[34:35], v[130:131], v[154:155], v[34:35] op_sel_hi:[1,0,1]
  v_pk_fma_f32 v[36:37], v[132:133], v[154:155], v[36:37] op_sel_hi:[1,0,1]
  v_pk_fma_f32 v[38:39], v[134:135], v[154:155], v[38:39] op_sel_hi:[1,0,1]
  ds_read_b128 v[120:123], v9 offset:40800
  ds_read_b128 v[124:127], v9 offset:40816
  ds_read_b128 v[128:131], v9 offset:40832
  ds_read_b128 v[132:135], v9 offset:40848
  s_add_u32 m0, s15, 90112
  s_add_u32 s6, s13, 196608
  buffer_load_dwordx4 v3, s[72:75], s6 offen lds
  s_waitcnt lgkmcnt(8)
  v_pk_fma_f32 v[24:25], v[88:89], v[154:155], v[24:25] op_sel:[0,1,0] op_sel_hi:[1,1,1]
  v_pk_fma_f32 v[26:27], v[90:91], v[154:155], v[26:27] op_sel:[0,1,0] op_sel_hi:[1,1,1]
  v_pk_fma_f32 v[28:29], v[92:93], v[154:155], v[28:29] op_sel:[0,1,0] op_sel_hi:[1,1,1]
  v_pk_fma_f32 v[30:31], v[94:95], v[154:155], v[30:31] op_sel:[0,1,0] op_sel_hi:[1,1,1]
  v_pk_fma_f32 v[32:33], v[96:97], v[154:155], v[32:33] op_sel:[0,1,0] op_sel_hi:[1,1,1]
  v_pk_fma_f32 v[34:35], v[98:99], v[154:155], v[34:35] op_sel:[0,1,0] op_sel_hi:[1,1,1]
  v_pk_fma_f32 v[36:37], v[100:101], v[154:155], v[36:37] op_sel:[0,1,0] op_sel_hi:[1,1,1]
  v_pk_fma_f32 v[38:39], v[102:103], v[154:155], v[38:39] op_sel:[0,1,0] op_sel_hi:[1,1,1]
  ds_read_b128 v[88:91], v9 offset:40256
  ds_read_b128 v[92:95], v9 offset:40272
  ds_read_b128 v[96:99], v9 offset:40288
  ds_read_b128 v[100:103], v9 offset:40304
  s_add_u32 m0, s15, 94208
  s_add_u32 s6, s13, 229376
  buffer_load_dwordx4 v3, s[72:75], s6 offen lds
  s_waitcnt lgkmcnt(8)
  v_pk_fma_f32 v[24:25], v[104:105], v[156:157], v[24:25] op_sel_hi:[1,0,1]
  v_pk_fma_f32 v[26:27], v[106:107], v[156:157], v[26:27] op_sel_hi:[1,0,1]
  v_pk_fma_f32 v[28:29], v[108:109], v[156:157], v[28:29] op_sel_hi:[1,0,1]
  v_pk_fma_f32 v[30:31], v[110:111], v[156:157], v[30:31] op_sel_hi:[1,0,1]
  v_pk_fma_f32 v[32:33], v[112:113], v[156:157], v[32:33] op_sel_hi:[1,0,1]
  v_pk_fma_f32 v[34:35], v[114:115], v[156:157], v[34:35] op_sel_hi:[1,0,1]
  v_pk_fma_f32 v[36:37], v[116:117], v[156:157], v[36:37] op_sel_hi:[1,0,1]
  v_pk_fma_f32 v[38:39], v[118:119], v[156:157], v[38:39] op_sel_hi:[1,0,1]
  ds_read_b128 v[104:107], v9 offset:39712
  ds_read_b128 v[108:111], v9 offset:39728
  ds_read_b128 v[112:115], v9 offset:39744
  ds_read_b128 v[116:119], v9 offset:39760
  s_waitcnt lgkmcnt(8)
  v_pk_fma_f32 v[24:25], v[120:121], v[156:157], v[24:25] op_sel:[0,1,0] op_sel_hi:[1,1,1]
  v_pk_fma_f32 v[26:27], v[122:123], v[156:157], v[26:27] op_sel:[0,1,0] op_sel_hi:[1,1,1]
  v_pk_fma_f32 v[28:29], v[124:125], v[156:157], v[28:29] op_sel:[0,1,0] op_sel_hi:[1,1,1]
  v_pk_fma_f32 v[30:31], v[126:127], v[156:157], v[30:31] op_sel:[0,1,0] op_sel_hi:[1,1,1]
  v_pk_fma_f32 v[32:33], v[128:129], v[156:157], v[32:33] op_sel:[0,1,0] op_sel_hi:[1,1,1]
  v_pk_fma_f32 v[34:35], v[130:131], v[156:157], v[34:35] op_sel:[0,1,0] op_sel_hi:[1,1,1]
  v_pk_fma_f32 v[36:37], v[132:133], v[156:157], v[36:37] op_sel:[0,1,0] op_sel_hi:[1,1,1]
  v_pk_fma_f32 v[38:39], v[134:135], v[156:157], v[38:39] op_sel:[0,1,0] op_sel_hi:[1,1,1]
  s_waitcnt lgkmcnt(4)
  v_pk_fma_f32 v[24:25], v[88:89], v[158:159], v[24:25] op_sel_hi:[1,0,1]
  v_pk_fma_f32 v[26:27], v[90:91], v[158:159], v[26:27] op_sel_hi:[1,0,1]
  v_pk_fma_f32 v[28:29], v[92:93], v[158:159], v[28:29] op_sel_hi:[1,0,1]
  v_pk_fma_f32 v[30:31], v[94:95], v[158:159], v[30:31] op_sel_hi:[1,0,1]
  v_pk_fma_f32 v[32:33], v[96:97], v[158:159], v[32:33] op_sel_hi:[1,0,1]
  v_pk_fma_f32 v[34:35], v[98:99], v[158:159], v[34:35] op_sel_hi:[1,0,1]
  v_pk_fma_f32 v[36:37], v[100:101], v[158:159], v[36:37] op_sel_hi:[1,0,1]
  v_pk_fma_f32 v[38:39], v[102:103], v[158:159], v[38:39] op_sel_hi:[1,0,1]
  s_waitcnt lgkmcnt(0)
  v_pk_fma_f32 v[24:25], v[104:105], v[158:159], v[24:25] op_sel:[0,1,0] op_sel_hi:[1,1,1]
  v_pk_fma_f32 v[26:27], v[106:107], v[158:159], v[26:27] op_sel:[0,1,0] op_sel_hi:[1,1,1]
  v_pk_fma_f32 v[28:29], v[108:109], v[158:159], v[28:29] op_sel:[0,1,0] op_sel_hi:[1,1,1]
  v_pk_fma_f32 v[30:31], v[110:111], v[158:159], v[30:31] op_sel:[0,1,0] op_sel_hi:[1,1,1]
  v_pk_fma_f32 v[32:33], v[112:113], v[158:159], v[32:33] op_sel:[0,1,0] op_sel_hi:[1,1,1]
  v_pk_fma_f32 v[34:35], v[114:115], v[158:159], v[34:35] op_sel:[0,1,0] op_sel_hi:[1,1,1]
  v_pk_fma_f32 v[36:37], v[116:117], v[158:159], v[36:37] op_sel:[0,1,0] op_sel_hi:[1,1,1]
  v_pk_fma_f32 v[38:39], v[118:119], v[158:159], v[38:39] op_sel:[0,1,0] op_sel_hi:[1,1,1]
  v_pk_mul_f32 v[24:25], v[24:25], v[14:15] op_sel_hi:[1,0]
  v_pk_mul_f32 v[26:27], v[26:27], v[14:15] op_sel_hi:[1,0]
  v_pk_mul_f32 v[28:29], v[28:29], v[14:15] op_sel_hi:[1,0]
  v_pk_mul_f32 v[30:31], v[30:31], v[14:15] op_sel_hi:[1,0]
  v_pk_mul_f32 v[32:33], v[32:33], v[14:15] op_sel_hi:[1,0]
  v_pk_mul_f32 v[34:35], v[34:35], v[14:15] op_sel_hi:[1,0]
  v_pk_mul_f32 v[36:37], v[36:37], v[14:15] op_sel_hi:[1,0]
  v_pk_mul_f32 v[38:39], v[38:39], v[14:15] op_sel_hi:[1,0]
  v_cvt_pk_bf16_f32 v136, v24, v25
  v_cvt_pk_bf16_f32 v137, v26, v27
  v_cvt_pk_bf16_f32 v138, v32, v33
  v_cvt_pk_bf16_f32 v139, v34, v35
  v_cvt_pk_bf16_f32 v140, v28, v29
  v_cvt_pk_bf16_f32 v141, v30, v31
  v_cvt_pk_bf16_f32 v142, v36, v37
  v_cvt_pk_bf16_f32 v143, v38, v39
  s_lshl_b32 s6, s11, 1
  s_add_u32 s6, s6, s78
  s_lshl_b32 s6, s6, 15
  s_lshl_b32 s7, s10, 12
  s_add_u32 s6, s6, s7
  s_lshl_b32 s7, s79, 11
  s_add_u32 s6, s6, s7
  s_add_u32 s6, s6, 1048576
  v_and_b32 v8, 31, v0
  v_lshlrev_b32 v8, 4, v8
  v_lshl_add_u32 v8, v10, 10, v8
  buffer_store_dwordx4 v[136:139], v8, s[60:63], s6 offen sc1
  buffer_store_dwordx4 v[140:143], v8, s[60:63], s6 offen offset:512 sc1
  s_waitcnt vmcnt(0)
  s_barrier
  s_cmp_lg_u32 s3, 4
  s_cbranch_scc1 L_hb2
  s_mov_b64 exec, 1
  v_mov_b32 v20, s76
  s_lshl_b32 s6, s77, 7
  s_add_u32 s6, s6, 557056
  buffer_store_dword v20, v164, s[60:63], s6 offen sc1
  s_mov_b64 exec, -1
L_hb2:
  s_cmp_lg_u32 s3, 5
  s_cbranch_scc1 L_nmode
  s_mov_b64 exec, 0xff
  v_lshlrev_b32 v21, 2, v0
  s_lshl_b32 s6, s5, 5
  s_add_u32 s6, s6, 622592
  s_mov_b32 s7, 0
L_pid:
  buffer_load_dword v20, v21, s[60:63], s6 offen sc1
  s_waitcnt vmcnt(0)
  v_and_b32 v22, 0xfffffff0, v20
  v_cmp_ne_u32 vcc, s76, v22
  s_add_u32 s7, s7, 1
  s_cmp_ge_u32 s7, 1048576
  s_cbranch_scc1 L_pid_x
  s_nop 1
  s_cbranch_vccnz L_pid
L_pid_x:
  v_readfirstlane_b32 s6, v20
  s_nop 1
  v_cmp_ne_u32 vcc, s6, v20
  s_nop 4
  s_cmp_eq_u64 vcc, 0
  s_cselect_b32 s6, 1, 0
  s_cmp_lt_u32 s7, 1048576
  s_cselect_b32 s6, s6, 0
  v_mov_b32 v20, s6
  v_mov_b32 v21, s76
  v_mov_b32 v22, 115712
  s_mov_b64 exec, 1
  ds_write_b64 v22, v[20:21]
  s_mov_b64 exec, -1
L_nmode:
  s_cmp_lg_u32 s79, 0
  s_cbranch_scc1 L_gl5
  s_add_u32 m0, s15, 129024
  s_add_u32 s6, s15, 129024
  buffer_load_dwordx4 v1, s[60:63], s6 offen sc1 lds
L_gl5:
  s_waitcnt vmcnt(8)
  s_add_u32 m0, s15, 116736
  s_add_u32 s6, s15, 116736
  buffer_load_dwordx4 v1, s[60:63], s6 offen sc1 lds
  s_waitcnt vmcnt(8)
  s_add_u32 m0, s15, 120832
  s_add_u32 s6, s15, 120832
  buffer_load_dwordx4 v1, s[60:63], s6 offen sc1 lds
  s_waitcnt vmcnt(8)
  s_add_u32 m0, s15, 124928
  s_add_u32 s6, s15, 124928
  buffer_load_dwordx4 v1, s[60:63], s6 offen sc1 lds
  s_waitcnt vmcnt(8)
  s_add_u32 m0, s15, 0
  s_add_u32 s6, s12, 0
  buffer_load_dwordx4 v3, s[56:59], s6 offen lds
  s_waitcnt vmcnt(8)
  s_add_u32 m0, s15, 4096
  s_add_u32 s6, s12, 32768
  buffer_load_dwordx4 v3, s[56:59], s6 offen lds
  s_waitcnt vmcnt(8)
  s_add_u32 m0, s15, 8192
  s_add_u32 s6, s12, 65536
  buffer_load_dwordx4 v3, s[56:59], s6 offen lds
  s_waitcnt vmcnt(8)
  s_add_u32 m0, s15, 12288
  s_add_u32 s6, s12, 98304
  buffer_load_dwordx4 v3, s[56:59], s6 offen lds
  s_waitcnt vmcnt(8)
  s_add_u32 m0, s15, 16384
  s_add_u32 s6, s12, 131072
  buffer_load_dwordx4 v3, s[56:59], s6 offen lds
  s_waitcnt vmcnt(8)
  s_add_u32 m0, s15, 20480
  s_add_u32 s6, s12, 163840
  buffer_load_dwordx4 v3, s[56:59], s6 offen lds
  s_waitcnt vmcnt(8)
  s_add_u32 m0, s15, 24576
  s_add_u32 s6, s12, 196608
  buffer_load_dwordx4 v3, s[56:59], s6 offen lds
  s_waitcnt vmcnt(8)
  s_add_u32 m0, s15, 28672
  s_add_u32 s6, s12, 229376
  buffer_load_dwordx4 v3, s[56:59], s6 offen lds
  s_waitcnt vmcnt(8)
  s_add_u32 m0, s15, 32768
  s_add_u32 s6, s12, 262144
  buffer_load_dwordx4 v3, s[56:59], s6 offen lds
  s_waitcnt vmcnt(8)
  s_add_u32 m0, s15, 36864
  s_add_u32 s6, s12, 294912
  buffer_load_dwordx4 v3, s[56:59], s6 offen lds
  s_waitcnt vmcnt(8)
  s_add_u32 m0, s15, 40960
  s_add_u32 s6, s12, 327680
  buffer_load_dwordx4 v3, s[56:59], s6 offen lds
  s_waitcnt vmcnt(8)
  s_add_u32 m0, s15, 45056
  s_add_u32 s6, s12, 360448
  buffer_load_dwordx4 v3, s[56:59], s6 offen lds
  s_waitcnt vmcnt(8)
  s_add_u32 m0, s15, 49152
  s_add_u32 s6, s12, 393216
  buffer_load_dwordx4 v3, s[56:59], s6 offen lds
  s_waitcnt vmcnt(8)
  s_add_u32 m0, s15, 53248
  s_add_u32 s6, s12, 425984
  buffer_load_dwordx4 v3, s[56:59], s6 offen lds
  s_waitcnt vmcnt(8)
  s_add_u32 m0, s15, 57344
  s_add_u32 s6, s12, 458752
  buffer_load_dwordx4 v3, s[56:59], s6 offen lds
  s_waitcnt vmcnt(8)
  s_add_u32 m0, s15, 61440
  s_add_u32 s6, s12, 491520
  buffer_load_dwordx4 v3, s[56:59], s6 offen lds
  s_waitcnt vmcnt(8)
  v_lshrrev_b32 v13, 5, v0
  v_bfe_u32 v14, v0, 2, 2
  v_lshl_add_u32 v12, v13, 2, v14
  v_lshlrev_b32 v12, 7, v12
  v_and_b32 v14, 2, v14
  v_bfe_u32 v13, v0, 4, 1
  v_xor_b32 v14, v14, v13
  v_lshl_add_u32 v12, v14, 5, v12
  v_and_b32 v14, 3, v0
  v_lshl_add_u32 v12, v14, 3, v12
  s_lshl_b32 s6, s78, 6
  v_xor_b32 v12, s6, v12
  v_and_b32 v9, 31, v0
  v_lshlrev_b32 v9, 11, v9
  v_lshrrev_b32 v10, 5, v0
  v_lshl_add_u32 v9, v10, 4, v9
  s_mov_b64 exec, 0xff
  s_lshl_b32 s6, s11, 10
  s_add_u32 s6, s6, 557056
  s_mov_b32 s7, 0
L_poa:
  buffer_load_dword v20, v166, s[60:63], s6 offen sc1
  s_waitcnt vmcnt(0)
  v_cmp_ne_u32 vcc, s76, v20
  s_add_u32 s7, s7, 1
  s_cmp_ge_u32 s7, 1048576
  s_cbranch_scc1 L_poa_x
  s_nop 1
  s_cbranch_vccnz L_poa
L_poa_x:
  s_mov_b64 exec, -1
  s_add_u32 s8, s82, 1048576
  buffer_load_dwordx4 v[24:27], v1, s[60:63], s8 offen offset:0 sc1
  s_waitcnt vmcnt(8)
  buffer_load_dwordx4 v[28:31], v1, s[60:63], s8 offen offset:1024 sc1
  s_waitcnt vmcnt(8)
  buffer_load_dwordx4 v[32:35], v1, s[60:63], s8 offen offset:2048 sc1
  s_waitcnt vmcnt(8)
  buffer_load_dwordx4 v[36:39], v1, s[60:63], s8 offen offset:3072 sc1
  s_waitcnt vmcnt(8)
  s_add_u32 s8, s82, 1052672
  buffer_load_dwordx4 v[40:43], v1, s[60:63], s8 offen offset:0 sc1
  s_waitcnt vmcnt(8)
  buffer_load_dwordx4 v[44:47], v1, s[60:63], s8 offen offset:1024 sc1
  s_waitcnt vmcnt(8)
  buffer_load_dwordx4 v[48:51], v1, s[60:63], s8 offen offset:2048 sc1
  s_waitcnt vmcnt(8)
  buffer_load_dwordx4 v[52:55], v1, s[60:63], s8 offen offset:3072 sc1
  s_waitcnt vmcnt(8)
  s_add_u32 s8, s82, 1056768
  buffer_load_dwordx4 v[56:59], v1, s[60:63], s8 offen offset:0 sc1
  s_waitcnt vmcnt(8)
  buffer_load_dwordx4 v[60:63], v1, s[60:63], s8 offen offset:1024 sc1
  s_waitcnt vmcnt(8)
  buffer_load_dwordx4 v[64:67], v1, s[60:63], s8 offen offset:2048 sc1
  s_waitcnt vmcnt(8)
  buffer_load_dwordx4 v[68:71], v1, s[60:63], s8 offen offset:3072 sc1
  s_waitcnt vmcnt(8)
  s_add_u32 s8, s82, 1060864
  buffer_load_dwordx4 v[72:75], v1, s[60:63], s8 offen offset:0 sc1
  s_waitcnt vmcnt(8)
  buffer_load_dwordx4 v[76:79], v1, s[60:63], s8 offen offset:1024 sc1
  s_waitcnt vmcnt(8)
  buffer_load_dwordx4 v[80:83], v1, s[60:63], s8 offen offset:2048 sc1
  s_waitcnt vmcnt(8)
  buffer_load_dwordx4 v[84:87], v1, s[60:63], s8 offen offset:3072 sc1
  s_waitcnt vmcnt(8)
  s_waitcnt lgkmcnt(0)
  s_barrier
  s_add_u32 m0, s15, 131072
  s_add_u32 s6, s13, 262144
  buffer_load_dwordx4 v3, s[72:75], s6 offen lds
  s_waitcnt vmcnt(8)
  s_add_u32 m0, s15, 135168
  s_add_u32 s6, s13, 294912
  buffer_load_dwordx4 v3, s[72:75], s6 offen lds
  s_waitcnt vmcnt(8)
  s_add_u32 m0, s15, 139264
  s_add_u32 s6, s13, 327680
  buffer_load_dwordx4 v3, s[72:75], s6 offen lds
  s_waitcnt vmcnt(8)
  s_add_u32 m0, s15, 143360
  s_add_u32 s6, s13, 360448
  buffer_load_dwordx4 v3, s[72:75], s6 offen lds
  s_waitcnt vmcnt(8)
  s_add_u32 m0, s15, 147456
  s_add_u32 s6, s13, 393216
  buffer_load_dwordx4 v3, s[72:75], s6 offen lds
  s_waitcnt vmcnt(8)
  s_add_u32 m0, s15, 151552
  s_add_u32 s6, s13, 425984
  buffer_load_dwordx4 v3, s[72:75], s6 offen lds
  s_waitcnt vmcnt(8)
  s_add_u32 m0, s15, 155648
  s_add_u32 s6, s13, 458752
  buffer_load_dwordx4 v3, s[72:75], s6 offen lds
  s_waitcnt vmcnt(8)
  s_add_u32 m0, s15, 159744
  s_add_u32 s6, s13, 491520
  buffer_load_dwordx4 v3, s[72:75], s6 offen lds
  s_waitcnt vmcnt(8)
  s_add_u32 s8, s82, 1064960
  buffer_load_dwordx4 v[88:91], v1, s[60:63], s8 offen offset:0 sc1
  s_waitcnt vmcnt(8)
  buffer_load_dwordx4 v[92:95], v1, s[60:63], s8 offen offset:1024 sc1
  s_waitcnt vmcnt(8)
  buffer_load_dwordx4 v[96:99], v1, s[60:63], s8 offen offset:2048 sc1
  s_waitcnt vmcnt(8)
  buffer_load_dwordx4 v[100:103], v1, s[60:63], s8 offen offset:3072 sc1
  s_waitcnt vmcnt(8)
  s_add_u32 s8, s82, 1069056
  buffer_load_dwordx4 v[104:107], v1, s[60:63], s8 offen offset:0 sc1
  s_waitcnt vmcnt(8)
  buffer_load_dwordx4 v[108:111], v1, s[60:63], s8 offen offset:1024 sc1
  s_waitcnt vmcnt(8)
  buffer_load_dwordx4 v[112:115], v1, s[60:63], s8 offen offset:2048 sc1
  s_waitcnt vmcnt(8)
  buffer_load_dwordx4 v[116:119], v1, s[60:63], s8 offen offset:3072 sc1
  s_waitcnt vmcnt(8)
  ds_read_b64_tr_b16 v[120:121], v12 offset:0
  ds_read_b64_tr_b16 v[122:123], v12 offset:1024
  s_waitcnt lgkmcnt(0)
  v_mfma_f32_32x32x16_bf16 v[148:163], v[120:123], v[24:27], 0
  ds_read_b64_tr_b16 v[124:125], v12 offset:2048
  ds_read_b64_tr_b16 v[126:127], v12 offset:3072
  s_waitcnt lgkmcnt(0)
  v_mfma_f32_32x32x16_bf16 v[148:163], v[124:127], v[28:31], v[148:163]
  ds_read_b64_tr_b16 v[128:129], v12 offset:4096
  ds_read_b64_tr_b16 v[130:131], v12 offset:5120
  s_waitcnt lgkmcnt(0)
  v_mfma_f32_32x32x16_bf16 v[148:163], v[128:131], v[32:35], v[148:163]
  ds_read_b64_tr_b16 v[132:133], v12 offset:6144
  ds_read_b64_tr_b16 v[134:135], v12 offset:7168
  s_waitcnt lgkmcnt(0)
  v_mfma_f32_32x32x16_bf16 v[148:163], v[132:135], v[36:39], v[148:163]
  ds_read_b64_tr_b16 v[136:137], v12 offset:8192
  ds_read_b64_tr_b16 v[138:139], v12 offset:9216
  s_waitcnt lgkmcnt(0)
  v_mfma_f32_32x32x16_bf16 v[148:163], v[136:139], v[40:43], v[148:163]
  ds_read_b64_tr_b16 v[140:141], v12 offset:10240
  ds_read_b64_tr_b16 v[142:143], v12 offset:11264
  s_waitcnt lgkmcnt(0)
  v_mfma_f32_32x32x16_bf16 v[148:163], v[140:143], v[44:47], v[148:163]
  ds_read_b64_tr_b16 v[144:145], v12 offset:12288
  ds_read_b64_tr_b16 v[146:147], v12 offset:13312
  s_waitcnt lgkmcnt(0)
  v_mfma_f32_32x32x16_bf16 v[148:163], v[144:147], v[48:51], v[148:163]
  ds_read_b64_tr_b16 v[120:121], v12 offset:14336
  ds_read_b64_tr_b16 v[122:123], v12 offset:15360
  s_waitcnt lgkmcnt(0)
  v_mfma_f32_32x32x16_bf16 v[148:163], v[120:123], v[52:55], v[148:163]
  s_add_u32 s8, s82, 1073152
  buffer_load_dwordx4 v[24:27], v1, s[60:63], s8 offen offset:0 sc1
  s_waitcnt vmcnt(8)
  buffer_load_dwordx4 v[28:31], v1, s[60:63], s8 offen offset:1024 sc1
  s_waitcnt vmcnt(8)
  buffer_load_dwordx4 v[32:35], v1, s[60:63], s8 offen offset:2048 sc1
  s_waitcnt vmcnt(8)
  buffer_load_dwordx4 v[36:39], v1, s[60:63], s8 offen offset:3072 sc1
  s_waitcnt vmcnt(8)
  s_add_u32 s8, s82, 1077248
  buffer_load_dwordx4 v[40:43], v1, s[60:63], s8 offen offset:0 sc1
  s_waitcnt vmcnt(8)
  buffer_load_dwordx4 v[44:47], v1, s[60:63], s8 offen offset:1024 sc1
  s_waitcnt vmcnt(8)
  buffer_load_dwordx4 v[48:51], v1, s[60:63], s8 offen offset:2048 sc1
  s_waitcnt vmcnt(8)
  buffer_load_dwordx4 v[52:55], v1, s[60:63], s8 offen offset:3072 sc1
  s_waitcnt vmcnt(8)
  s_waitcnt vmcnt(0)
  s_waitcnt lgkmcnt(0)
  ds_read_b64_tr_b16 v[124:125], v12 offset:16384
  ds_read_b64_tr_b16 v[126:127], v12 offset:17408
  ds_read_b64_tr_b16 v[128:129], v12 offset:18432
  ds_read_b64_tr_b16 v[130:131], v12 offset:19456
  ds_read_b64_tr_b16 v[132:133], v12 offset:20480
  ds_read_b64_tr_b16 v[134:135], v12 offset:21504
  ds_read_b64_tr_b16 v[136:137], v12 offset:22528
  ds_read_b64_tr_b16 v[138:139], v12 offset:23552
  ds_read_b64_tr_b16 v[140:141], v12 offset:24576
  ds_read_b64_tr_b16 v[142:143], v12 offset:25600
  ds_read_b64_tr_b16 v[144:145], v12 offset:26624
  ds_read_b64_tr_b16 v[146:147], v12 offset:27648
  s_setprio 0
  s_barrier
  s_waitcnt lgkmcnt(10)
  v_mfma_f32_32x32x16_bf16 v[148:163], v[124:127], v[56:59], v[148:163]
  ds_read_b64_tr_b16 v[120:121], v12 offset:28672
  ds_read_b64_tr_b16 v[122:123], v12 offset:29696
  s_waitcnt lgkmcnt(10)
  v_mfma_f32_32x32x16_bf16 v[148:163], v[128:131], v[60:63], v[148:163]
  ds_read_b64_tr_b16 v[124:125], v12 offset:30720
  ds_read_b64_tr_b16 v[126:127], v12 offset:31744
  s_waitcnt lgkmcnt(10)
  v_mfma_f32_32x32x16_bf16 v[148:163], v[132:135], v[64:67], v[148:163]
  ds_read_b64_tr_b16 v[128:129], v12 offset:32768
  ds_read_b64_tr_b16 v[130:131], v12 offset:33792
  s_waitcnt lgkmcnt(10)
  v_mfma_f32_32x32x16_bf16 v[148:163], v[136:139], v[68:71], v[148:163]
  ds_read_b64_tr_b16 v[132:133], v12 offset:34816
  ds_read_b64_tr_b16 v[134:135], v12 offset:35840
  s_waitcnt lgkmcnt(10)
  v_mfma_f32_32x32x16_bf16 v[148:163], v[140:143], v[72:75], v[148:163]
  ds_read_b64_tr_b16 v[136:137], v12 offset:36864
  ds_read_b64_tr_b16 v[138:139], v12 offset:37888
  s_waitcnt lgkmcnt(10)
  v_mfma_f32_32x32x16_bf16 v[148:163], v[144:147], v[76:79], v[148:163]
  ds_read_b64_tr_b16 v[140:141], v12 offset:38912
  ds_read_b64_tr_b16 v[142:143], v12 offset:39936
  s_waitcnt lgkmcnt(10)
  v_mfma_f32_32x32x16_bf16 v[148:163], v[120:123], v[80:83], v[148:163]
  ds_read_b64_tr_b16 v[144:145], v12 offset:40960
  ds_read_b64_tr_b16 v[146:147], v12 offset:41984
  s_waitcnt lgkmcnt(10)
  v_mfma_f32_32x32x16_bf16 v[148:163], v[124:127], v[84:87], v[148:163]
  ds_read_b64_tr_b16 v[120:121], v12 offset:43008
  ds_read_b64_tr_b16 v[122:123], v12 offset:44032
  s_waitcnt lgkmcnt(10)
  v_mfma_f32_32x32x16_bf16 v[148:163], v[128:131], v[88:91], v[148:163]
  ds_read_b64_tr_b16 v[124:125], v12 offset:45056
  ds_read_b64_tr_b16 v[126:127], v12 offset:46080
  s_waitcnt lgkmcnt(10)
  v_mfma_f32_32x32x16_bf16 v[148:163], v[132:135], v[92:95], v[148:163]
  ds_read_b64_tr_b16 v[128:129], v12 offset:47104
  ds_read_b64_tr_b16 v[130:131], v12 offset:48128
  s_waitcnt lgkmcnt(10)
  v_mfma_f32_32x32x16_bf16 v[148:163], v[136:139], v[96:99], v[148:163]
  ds_read_b64_tr_b16 v[132:133], v12 offset:49152
  ds_read_b64_tr_b16 v[134:135], v12 offset:50176
  s_waitcnt lgkmcnt(10)
  v_mfma_f32_32x32x16_bf16 v[148:163], v[140:143], v[100:103], v[148:163]
  ds_read_b64_tr_b16 v[136:137], v12 offset:51200
  ds_read_b64_tr_b16 v[138:139], v12 offset:52224
  s_waitcnt lgkmcnt(10)
  v_mfma_f32_32x32x16_bf16 v[148:163], v[144:147], v[104:107], v[148:163]
  ds_read_b64_tr_b16 v[140:141], v12 offset:53248
  ds_read_b64_tr_b16 v[142:143], v12 offset:54272
  s_waitcnt lgkmcnt(10)
  v_mfma_f32_32x32x16_bf16 v[148:163], v[120:123], v[108:111], v[148:163]
  ds_read_b64_tr_b16 v[144:145], v12 offset:55296
  ds_read_b64_tr_b16 v[146:147], v12 offset:56320
  s_waitcnt lgkmcnt(10)
  v_mfma_f32_32x32x16_bf16 v[148:163], v[124:127], v[112:115], v[148:163]
  ds_read_b64_tr_b16 v[120:121], v12 offset:57344
  ds_read_b64_tr_b16 v[122:123], v12 offset:58368
  s_waitcnt lgkmcnt(10)
  v_mfma_f32_32x32x16_bf16 v[148:163], v[128:131], v[116:119], v[148:163]
  ds_read_b64_tr_b16 v[124:125], v12 offset:59392
  ds_read_b64_tr_b16 v[126:127], v12 offset:60416
  s_waitcnt lgkmcnt(10)
  v_mfma_f32_32x32x16_bf16 v[148:163], v[132:135], v[24:27], v[148:163]
  ds_read_b64_tr_b16 v[128:129], v12 offset:61440
  ds_read_b64_tr_b16 v[130:131], v12 offset:62464
  s_waitcnt lgkmcnt(10)
  v_mfma_f32_32x32x16_bf16 v[148:163], v[136:139], v[28:31], v[148:163]
  ds_read_b64_tr_b16 v[132:133], v12 offset:63488
  ds_read_b64_tr_b16 v[134:135], v12 offset:64512
  s_waitcnt lgkmcnt(10)
  v_mfma_f32_32x32x16_bf16 v[148:163], v[140:143], v[32:35], v[148:163]
  s_waitcnt lgkmcnt(8)
  v_mfma_f32_32x32x16_bf16 v[148:163], v[144:147], v[36:39], v[148:163]
  s_waitcnt lgkmcnt(6)
  v_mfma_f32_32x32x16_bf16 v[148:163], v[120:123], v[40:43], v[148:163]
  s_waitcnt lgkmcnt(4)
  v_mfma_f32_32x32x16_bf16 v[148:163], v[124:127], v[44:47], v[148:163]
  s_waitcnt lgkmcnt(2)
  v_mfma_f32_32x32x16_bf16 v[148:163], v[128:131], v[48:51], v[148:163]
  s_waitcnt lgkmcnt(0)
  v_mfma_f32_32x32x16_bf16 v[148:163], v[132:135], v[52:55], v[148:163]
  s_nop 11
  v_cvt_pk_bf16_f32 v24, v148, v149
  v_cvt_pk_bf16_f32 v25, v150, v151
  v_cvt_pk_bf16_f32 v26, v152, v153
  v_cvt_pk_bf16_f32 v27, v154, v155
  v_cvt_pk_bf16_f32 v28, v156, v157
  v_cvt_pk_bf16_f32 v29, v158, v159
  v_cvt_pk_bf16_f32 v30, v160, v161
  v_cvt_pk_bf16_f32 v31, v162, v163
  v_and_b32 v13, 31, v0
  v_mul_u32_u24 v13, 144, v13
  v_lshl_add_u32 v13, v10, 3, v13
  s_mul_i32 s6, s79, 4608
  s_lshl_b32 s7, s78, 6
  s_add_u32 s6, s6, s7
  v_add_u32 v13, s6, v13
  v_lshrrev_b32 v14, 3, v0
  v_and_b32 v15, 7, v0
  v_lshlrev_b32 v15, 4, v15
  v_lshl_add_u32 v9, v14, 11, v15
  v_mul_u32_u24 v14, 144, v14
  v_add_u32 v14, v14, v15
  s_mul_i32 s6, s86, 2304
  v_add_u32 v14, s6, v14
  s_lshl_b32 s83, s11, 17
  s_lshl_b32 s7, s86, 15
  s_add_u32 s83, s83, s7
  s_lshl_b32 s7, s10, 7
  s_add_u32 s83, s83, s7
  s_add_u32 s8, s83, 16384
  s_barrier
  ds_write_b64 v13, v[24:25] offset:0
  ds_write_b64 v13, v[26:27] offset:16
  ds_write_b64 v13, v[28:29] offset:32
  ds_write_b64 v13, v[30:31] offset:48
  s_waitcnt lgkmcnt(0)
  s_barrier
  ds_read_b128 v[32:35], v14
  ds_read_b128 v[36:39], v14 offset:1152
  s_waitcnt lgkmcnt(1)
  buffer_store_dwordx4 v[32:35], v9, s[68:71], s83 offen sc1
  s_waitcnt lgkmcnt(0)
  buffer_store_dwordx4 v[36:39], v9, s[68:71], s8 offen sc1
L_fin:
L_end:
  s_endpgm
L_fba:
  v_mov_b32 v40, 0xff800000
  s_mov_b32 s6, 0
L_fb1a:
  buffer_load_dwordx4 v[128:131], v1, s[60:63], s6 offen sc1
  s_waitcnt vmcnt(0)
  v_mfma_f32_32x32x16_bf16 v[24:39], v[128:131], v[16:19], 0
  s_add_u32 s6, s6, 2048
  s_nop 10
  v_max3_f32 v40, v40, v24, v25
  v_max3_f32 v40, v40, v26, v27
  v_max3_f32 v40, v40, v28, v29
  v_max3_f32 v40, v40, v30, v31
  v_max3_f32 v40, v40, v32, v33
  v_max3_f32 v40, v40, v34, v35
  v_max3_f32 v40, v40, v36, v37
  v_max3_f32 v40, v40, v38, v39
  s_cmp_lt_u32 s6, 131072
  s_cbranch_scc1 L_fb1a
  v_mov_b32 v41, v40
  s_nop 1
  v_permlane32_swap_b32 v40, v41
  v_max_f32 v56, v40, v41
  v_sub_f32 v56, 0xc1400000, v56
  v_mov_b32 v57, v56
  v_mov_b32 v58, v56
  v_mov_b32 v59, v56
  v_mov_b32 v60, v56
  v_mov_b32 v61, v56
  v_mov_b32 v62, v56
  v_mov_b32 v63, v56
  v_mov_b32 v64, v56
  v_mov_b32 v65, v56
  v_mov_b32 v66, v56
  v_mov_b32 v67, v56
  v_mov_b32 v68, v56
  v_mov_b32 v69, v56
  v_mov_b32 v70, v56
  v_mov_b32 v71, v56
  v_mov_b32 v88, 0
  v_mov_b32 v89, 0
  v_mov_b32 v90, 0
  v_mov_b32 v91, 0
  v_mov_b32 v92, 0
  v_mov_b32 v93, 0
  v_mov_b32 v94, 0
  v_mov_b32 v95, 0
  v_mov_b32 v96, 0
  v_mov_b32 v97, 0
  v_mov_b32 v98, 0
  v_mov_b32 v99, 0
  v_mov_b32 v100, 0
  v_mov_b32 v101, 0
  v_mov_b32 v102, 0
  v_mov_b32 v103, 0
  s_mov_b32 s6, 0
L_fb2a:
  buffer_load_dwordx4 v[128:131], v1, s[60:63], s6 offen sc1
  s_mov_b64 exec, s[92:93]
  buffer_load_dwordx4 v[132:135], v11, s[60:63], s6 offen offset:1024 sc1
  buffer_load_dwordx4 v[136:139], v11, s[60:63], s6 offen offset:1536 sc1
  s_mov_b64 exec, -1
  s_waitcnt vmcnt(0)
  v_mfma_f32_32x32x16_bf16 v[24:39], v[128:131], v[16:19], v[56:71]
  s_add_u32 s6, s6, 2048
  s_nop 10
  v_exp_f32 v24, v24
  v_exp_f32 v25, v25
  v_exp_f32 v26, v26
  v_exp_f32 v27, v27
  v_exp_f32 v28, v28
  v_exp_f32 v29, v29
  v_exp_f32 v30, v30
  v_exp_f32 v31, v31
  v_exp_f32 v32, v32
  v_exp_f32 v33, v33
  v_exp_f32 v34, v34
  v_exp_f32 v35, v35
  v_exp_f32 v36, v36
  v_exp_f32 v37, v37
  v_exp_f32 v38, v38
  v_exp_f32 v39, v39
  s_nop 0
  v_cvt_pk_bf16_f32 v120, v24, v25
  v_cvt_pk_bf16_f32 v121, v26, v27
  v_cvt_pk_bf16_f32 v122, v28, v29
  v_cvt_pk_bf16_f32 v123, v30, v31
  v_cvt_pk_bf16_f32 v124, v32, v33
  v_cvt_pk_bf16_f32 v125, v34, v35
  v_cvt_pk_bf16_f32 v126, v36, v37
  v_cvt_pk_bf16_f32 v127, v38, v39
  s_nop 1
  v_mfma_f32_32x32x16_bf16 v[88:103], v[132:135], v[120:123], v[88:103]
  v_mfma_f32_32x32x16_bf16 v[88:103], v[136:139], v[124:127], v[88:103]
  s_cmp_lt_u32 s6, 131072
  s_cbranch_scc1 L_fb2a
  s_nop 11
  v_rcp_f32 v72, v96
  s_nop 0
  v_mul_f32 v88, v88, v72
  v_mul_f32 v89, v89, v72
  v_mul_f32 v90, v90, v72
  v_mul_f32 v91, v91, v72
  v_mul_f32 v92, v92, v72
  v_mul_f32 v93, v93, v72
  v_mul_f32 v94, v94, v72
  v_mul_f32 v95, v95, v72
  s_branch L_fbra
L_fbb:
  v_mov_b32 v40, 0xff800000
  s_mov_b32 s6, 0
L_fb1b:
  buffer_load_dwordx4 v[128:131], v1, s[60:63], s6 offen sc1
  s_waitcnt vmcnt(0)
  v_mfma_f32_32x32x16_bf16 v[24:39], v[128:131], v[20:23], 0
  s_add_u32 s6, s6, 2048
  s_nop 10
  v_max3_f32 v40, v40, v24, v25
  v_max3_f32 v40, v40, v26, v27
  v_max3_f32 v40, v40, v28, v29
  v_max3_f32 v40, v40, v30, v31
  v_max3_f32 v40, v40, v32, v33
  v_max3_f32 v40, v40, v34, v35
  v_max3_f32 v40, v40, v36, v37
  v_max3_f32 v40, v40, v38, v39
  s_cmp_lt_u32 s6, 131072
  s_cbranch_scc1 L_fb1b
  v_mov_b32 v41, v40
  s_nop 1
  v_permlane32_swap_b32 v40, v41
  v_max_f32 v56, v40, v41
  v_sub_f32 v56, 0xc1400000, v56
  v_mov_b32 v57, v56
  v_mov_b32 v58, v56
  v_mov_b32 v59, v56
  v_mov_b32 v60, v56
  v_mov_b32 v61, v56
  v_mov_b32 v62, v56
  v_mov_b32 v63, v56
  v_mov_b32 v64, v56
  v_mov_b32 v65, v56
  v_mov_b32 v66, v56
  v_mov_b32 v67, v56
  v_mov_b32 v68, v56
  v_mov_b32 v69, v56
  v_mov_b32 v70, v56
  v_mov_b32 v71, v56
  v_mov_b32 v104, 0
  v_mov_b32 v105, 0
  v_mov_b32 v106, 0
  v_mov_b32 v107, 0
  v_mov_b32 v108, 0
  v_mov_b32 v109, 0
  v_mov_b32 v110, 0
  v_mov_b32 v111, 0
  v_mov_b32 v112, 0
  v_mov_b32 v113, 0
  v_mov_b32 v114, 0
  v_mov_b32 v115, 0
  v_mov_b32 v116, 0
  v_mov_b32 v117, 0
  v_mov_b32 v118, 0
  v_mov_b32 v119, 0
  s_mov_b32 s6, 0
L_fb2b:
  buffer_load_dwordx4 v[128:131], v1, s[60:63], s6 offen sc1
  s_mov_b64 exec, s[92:93]
  buffer_load_dwordx4 v[132:135], v11, s[60:63], s6 offen offset:1024 sc1
  buffer_load_dwordx4 v[136:139], v11, s[60:63], s6 offen offset:1536 sc1
  s_mov_b64 exec, -1
  s_waitcnt vmcnt(0)
  v_mfma_f32_32x32x16_bf16 v[24:39], v[128:131], v[20:23], v[56:71]
  s_add_u32 s6, s6, 2048
  s_nop 10
  v_exp_f32 v24, v24
  v_exp_f32 v25, v25
  v_exp_f32 v26, v26
  v_exp_f32 v27, v27
  v_exp_f32 v28, v28
  v_exp_f32 v29, v29
  v_exp_f32 v30, v30
  v_exp_f32 v31, v31
  v_exp_f32 v32, v32
  v_exp_f32 v33, v33
  v_exp_f32 v34, v34
  v_exp_f32 v35, v35
  v_exp_f32 v36, v36
  v_exp_f32 v37, v37
  v_exp_f32 v38, v38
  v_exp_f32 v39, v39
  s_nop 0
  v_cvt_pk_bf16_f32 v120, v24, v25
  v_cvt_pk_bf16_f32 v121, v26, v27
  v_cvt_pk_bf16_f32 v122, v28, v29
  v_cvt_pk_bf16_f32 v123, v30, v31
  v_cvt_pk_bf16_f32 v124, v32, v33
  v_cvt_pk_bf16_f32 v125, v34, v35
  v_cvt_pk_bf16_f32 v126, v36, v37
  v_cvt_pk_bf16_f32 v127, v38, v39
  s_nop 1
  v_mfma_f32_32x32x16_bf16 v[104:119], v[132:135], v[120:123], v[104:119]
  v_mfma_f32_32x32x16_bf16 v[104:119], v[136:139], v[124:127], v[104:119]
  s_cmp_lt_u32 s6, 131072
  s_cbranch_scc1 L_fb2b
  s_nop 11
  v_rcp_f32 v72, v112
  s_nop 0
  v_mul_f32 v104, v104, v72
  v_mul_f32 v105, v105, v72
  v_mul_f32 v106, v106, v72
  v_mul_f32 v107, v107, v72
  v_mul_f32 v108, v108, v72
  v_mul_f32 v109, v109, v72
  v_mul_f32 v110, v110, v72
  v_mul_f32 v111, v111, v72
  s_branch L_fbrb
.section .rodata,"a"
.p2align 6
.amdhsa_kernel concat_heads__sliding_local_dilated__grouped_kv_mqa__prompt_kernel
  .amdhsa_next_free_vgpr 168
  .amdhsa_next_free_sgpr 102
  .amdhsa_accum_offset 168
  .amdhsa_group_segment_fixed_size 0
  .amdhsa_kernarg_size 88
  .amdhsa_user_sgpr_count 2
  .amdhsa_user_sgpr_kernarg_segment_ptr 1
  .amdhsa_system_sgpr_workgroup_id_x 1
.end_amdhsa_kernel
```
